```python
import torch

def _softmax(x, axis=-1):
    return torch.softmax(x, dim=axis)
def _gelu(x):
    return torch.nn.functional.gelu(x, approximate="tanh")
def _silu(x):
    return torch.nn.functional.silu(x)
def _sigmoid(x):
    return torch.sigmoid(x)
def _layernorm(x, axis=-1, eps=1e-5):
    m = x.mean(dim=axis, keepdim=True)
    v = x.var(dim=axis, keepdim=True, unbiased=False)
    return (x - m) / torch.sqrt(v + eps)
def _scatter_add(tgt, idx, src, axis=0):
    return tgt.clone().index_add_(axis, idx, src)
def _segment_sum(src, seg, n):
    out = torch.zeros((n,) + src.shape[1:], dtype=src.dtype)
    return out.index_add_(0, seg, src)
def _pad(x, pw):
    flat = tuple(v for pair in reversed(pw) for v in pair)
    return torch.nn.functional.pad(x, flat)

kernel_name = 'concat_heads__gqa_block_cached__gqa_block_cached__near_ridge'

def setup_inputs():

    _w = (lambda a: (lambda t: t.to(torch.bfloat16) if t.is_floating_point() else t)(torch.as_tensor(a)))
    def _A_setup():
        B, Sq, D = 16, 64, 448
        Hq, Hkv, Sk, Dh = 16, 8, 1024, 256
        assert Hq % Hkv == 0, (Hq, Hkv)
        return {
            "x": _w((lambda *s: torch.randn(*s, dtype=torch.bfloat16) * 0.8)(B, Sq, D)),
            "k_cache": _w((lambda *s: torch.randn(*s, dtype=torch.bfloat16) * 0.8)(B, Hkv, Sk, Dh)),
            "v_cache": _w((lambda *s: torch.randn(*s, dtype=torch.bfloat16) * 0.05)(B, Hkv, Sk, Dh)),
            "wq": _w((lambda *s: torch.randn(*s, dtype=torch.bfloat16) * 0.8)(D, Hq * Dh) * (D ** -0.5)),
            "wo": _w((lambda *s: torch.randn(*s, dtype=torch.bfloat16) * 0.05)(Hq * Dh, D) * ((Hq * Dh) ** -0.5)),
        }
    _A_in = _A_setup()

    def _B_setup():
        B, Sq, D = 16, 64, 448
        Hq, Hkv, Sk, Dh = 16, 8, 1024, 256
        assert Hq % Hkv == 0, (Hq, Hkv)
        return {
            "x": _w((lambda *s: torch.randn(*s, dtype=torch.bfloat16) * 0.8)(B, Sq, D)),
            "k_cache": _w((lambda *s: torch.randn(*s, dtype=torch.bfloat16) * 0.8)(B, Hkv, Sk, Dh)),
            "v_cache": _w((lambda *s: torch.randn(*s, dtype=torch.bfloat16) * 0.05)(B, Hkv, Sk, Dh)),
            "wq": _w((lambda *s: torch.randn(*s, dtype=torch.bfloat16) * 0.8)(D, Hq * Dh) * (D ** -0.5)),
            "wo": _w((lambda *s: torch.randn(*s, dtype=torch.bfloat16) * 0.05)(Hq * Dh, D) * ((Hq * Dh) ** -0.5)),
        }
    _B_in = _B_setup()

    return {
        "A_x": _A_in["x"],
        "A_k_cache": _A_in["k_cache"],
        "A_v_cache": _A_in["v_cache"],
        "A_wq": _A_in["wq"],
        "A_wo": _A_in["wo"],
        "B_x": _B_in["x"],
        "B_k_cache": _B_in["k_cache"],
        "B_v_cache": _B_in["v_cache"],
        "B_wq": _B_in["wq"],
        "B_wo": _B_in["wo"],
    }

def reference(A_x, A_k_cache, A_v_cache, A_wq, A_wo, B_x, B_k_cache, B_v_cache, B_wq, B_wo):
    def _A_ref(x, k_cache, v_cache, wq, wo):
        B, Sq, D = x.shape
        Hq, Dh = 16, 256
        Hkv = k_cache.shape[1]
        rep = Hq // Hkv
        q = (lambda x, *d: x.permute(*d))((x @ wq).reshape(B, Sq, Hq, Dh), 0, 2, 1, 3)
        k = (lambda x, n, axis: torch.repeat_interleave(x, n, dim=axis))(k_cache, rep, axis=1)
        v = (lambda x, n, axis: torch.repeat_interleave(x, n, dim=axis))(v_cache, rep, axis=1)
        scores = torch.einsum("bhqd,bhkd->bhqk", q, k) * (Dh ** -0.5)
        p = _softmax(scores, axis=-1)
        o = torch.einsum("bhqk,bhkd->bhqd", p, v)
        return (lambda x, *d: x.permute(*d))(o, 0, 2, 1, 3).reshape(B, Sq, Hq * Dh) @ wo

    def _B_ref(x, k_cache, v_cache, wq, wo):
        B, Sq, D = x.shape
        Hq, Dh = 16, 256
        Hkv = k_cache.shape[1]
        rep = Hq // Hkv
        q = (lambda x, *d: x.permute(*d))((x @ wq).reshape(B, Sq, Hq, Dh), 0, 2, 1, 3)
        k = (lambda x, n, axis: torch.repeat_interleave(x, n, dim=axis))(k_cache, rep, axis=1)
        v = (lambda x, n, axis: torch.repeat_interleave(x, n, dim=axis))(v_cache, rep, axis=1)
        scores = torch.einsum("bhqd,bhkd->bhqk", q, k) * (Dh ** -0.5)
        p = _softmax(scores, axis=-1)
        o = torch.einsum("bhqk,bhkd->bhqd", p, v)
        return (lambda x, *d: x.permute(*d))(o, 0, 2, 1, 3).reshape(B, Sq, Hq * Dh) @ wo

    a = _A_ref(A_x, A_k_cache, A_v_cache, A_wq, A_wo)
    b = _B_ref(B_x, B_k_cache, B_v_cache, B_wq, B_wo)
    return torch.concatenate([a, b], axis=-1)
```

```asm
; @launch kernel=concat_heads__gqa_block_cached__gqa_block_cached__near_ridge_kernel grid=(256,1,1) block=(512,1,1) lds=163840
; @launch kernel=reduce_partials_kernel grid=(448,1,1) block=(256,1,1) lds=0
.amdgcn_target "amdgcn-amd-amdhsa--gfx950"
.text
.globl concat_heads__gqa_block_cached__gqa_block_cached__near_ridge_kernel
.p2align 8
.type concat_heads__gqa_block_cached__gqa_block_cached__near_ridge_kernel,@function
concat_heads__gqa_block_cached__gqa_block_cached__near_ridge_kernel:
    s_cmp_ge_u32 s2, 256
    s_cbranch_scc1 L_exit
    s_load_dwordx16 s[8:23], s[0:1], 0
    s_load_dwordx8 s[24:31], s[0:1], 64
    s_load_dwordx2 s[32:33], s[0:1], 96
    s_and_b32 s60, s2, 7
    s_lshl_b32 s60, s60, 1
    s_lshr_b32 s61, s2, 3
    s_and_b32 s61, s61, 1
    s_add_u32 s60, s60, s61
    s_lshr_b32 s36, s2, 4
    s_lshr_b32 s34, s60, 3
    s_and_b32 s35, s60, 7
    v_lshrrev_b32 v1, 6, v0
    v_and_b32 v254, 63, v0
    s_nop 0
    v_readfirstlane_b32 s37, v1
    s_waitcnt lgkmcnt(0)
    s_cmp_eq_u32 s34, 0
    s_cselect_b64 s[64:65], s[8:9], s[18:19]
    s_cselect_b64 s[66:67], s[10:11], s[20:21]
    s_cselect_b64 s[68:69], s[12:13], s[22:23]
    s_cselect_b64 s[70:71], s[14:15], s[24:25]
    s_cselect_b64 s[72:73], s[16:17], s[26:27]
    s_cmp_ge_u32 s37, 4
    s_cbranch_scc1 L_producer
    s_lshl_b32 s60, s34, 4
    s_add_u32 s60, s60, s36
    s_lshl_b32 s60, s60, 3
    s_add_u32 s60, s60, s35
    s_mul_i32 s60, s60, 57344
    s_add_u32 s48, s32, s60
    s_addc_u32 s49, s33, 0
    s_mov_b32 s50, 57344
    s_mov_b32 s51, 0x00020000
    s_lshr_b32 s58, s37, 1
    s_and_b32 s59, s37, 1
    v_lshrrev_b32 v242, 4, v254
    v_and_b32 v243, 15, v254
    v_bfe_u32 v244, v254, 2, 2
    v_and_b32 v245, 3, v254
    s_mul_i32 s53, s37, 16384
    s_add_u32 s53, s53, 65536
    s_mul_i32 s97, s36, 7
    s_lshr_b32 s97, s97, 3
    v_mul_u32_u24 v128, 896, v243
    v_bfe_u32 v129, v254, 1, 3
    v_lshlrev_b32 v246, 3, v242
    v_add_u32 v246, v246, v244
    v_lshlrev_b32 v246, 7, v246
    v_lshlrev_b32 v247, 4, v245
    v_add_u32 v246, v246, v247
    v_add_u32 v246, s53, v246
    v_lshrrev_b32 v247, 1, v244
    v_xor_b32 v247, 0, v247
    v_lshlrev_b32 v247, 6, v247
    v_add_u32 v132, v246, v247
    v_lshrrev_b32 v247, 1, v244
    v_xor_b32 v247, 1, v247
    v_lshlrev_b32 v247, 6, v247
    v_add_u32 v133, v246, v247
    v_xor_b32 v247, v242, v243
    v_lshlrev_b32 v247, 4, v247
    v_lshlrev_b32 v246, 9, v243
    v_add_u32 v246, v246, v247
    v_add_u32 v232, 131072, v246
    v_lshlrev_b32 v246, 2, v242
    v_add_u32 v246, v246, v244
    v_and_b32 v247, 7, v246
    v_lshlrev_b32 v247, 5, v247
    v_lshlrev_b32 v246, 9, v246
    v_add_u32 v246, v246, v247
    v_lshlrev_b32 v247, 3, v245
    v_add_u32 v246, v246, v247
    v_add_u32 v233, 147456, v246
    s_barrier
    s_lshl_b32 s60, s97, 2
    s_add_u32 s97, s97, 1
    s_cmp_ge_u32 s97, 14
    s_cselect_b32 s97, 0, s97
    v_add_u32 v130, s60, v242
    v_xor_b32 v130, v130, v129
    v_lshlrev_b32 v130, 4, v130
    v_add_u32 v130, v130, v128
    ds_read_b128 v[136:139], v130 offset:0
    ds_read_b128 v[140:143], v130 offset:14336
    ds_read_b128 v[144:147], v130 offset:28672
    ds_read_b128 v[148:151], v130 offset:43008
    ds_read_b64_tr_b16 v[168:169], v132 offset:0
    ds_read_b64_tr_b16 v[170:171], v132 offset:512
    ds_read_b64_tr_b16 v[172:173], v132 offset:8
    ds_read_b64_tr_b16 v[174:175], v132 offset:520
    ds_read_b64_tr_b16 v[176:177], v133 offset:0
    ds_read_b64_tr_b16 v[178:179], v133 offset:512
    ds_read_b64_tr_b16 v[180:181], v133 offset:8
    ds_read_b64_tr_b16 v[182:183], v133 offset:520
    s_waitcnt lgkmcnt(6)
    v_mfma_f32_16x16x32_bf16 v[0:3], v[168:171], v[136:139], 0
    v_mfma_f32_16x16x32_bf16 v[4:7], v[168:171], v[140:143], 0
    v_mfma_f32_16x16x32_bf16 v[8:11], v[168:171], v[144:147], 0
    v_mfma_f32_16x16x32_bf16 v[12:15], v[168:171], v[148:151], 0
    s_waitcnt lgkmcnt(0)
    s_barrier
    ds_read_b64_tr_b16 v[184:185], v132 offset:4096
    ds_read_b64_tr_b16 v[186:187], v132 offset:4608
    v_mfma_f32_16x16x32_bf16 v[16:19], v[172:175], v[136:139], 0
    v_mfma_f32_16x16x32_bf16 v[20:23], v[172:175], v[140:143], 0
    v_mfma_f32_16x16x32_bf16 v[24:27], v[172:175], v[144:147], 0
    v_mfma_f32_16x16x32_bf16 v[28:31], v[172:175], v[148:151], 0
    ds_read_b64_tr_b16 v[188:189], v132 offset:4104
    ds_read_b64_tr_b16 v[190:191], v132 offset:4616
    v_mfma_f32_16x16x32_bf16 v[32:35], v[176:179], v[136:139], 0
    v_mfma_f32_16x16x32_bf16 v[36:39], v[176:179], v[140:143], 0
    v_mfma_f32_16x16x32_bf16 v[40:43], v[176:179], v[144:147], 0
    v_mfma_f32_16x16x32_bf16 v[44:47], v[176:179], v[148:151], 0
    ds_read_b64_tr_b16 v[192:193], v133 offset:4096
    ds_read_b64_tr_b16 v[194:195], v133 offset:4608
    v_mfma_f32_16x16x32_bf16 v[48:51], v[180:183], v[136:139], 0
    v_mfma_f32_16x16x32_bf16 v[52:55], v[180:183], v[140:143], 0
    v_mfma_f32_16x16x32_bf16 v[56:59], v[180:183], v[144:147], 0
    v_mfma_f32_16x16x32_bf16 v[60:63], v[180:183], v[148:151], 0
    ds_read_b64_tr_b16 v[196:197], v133 offset:4104
    ds_read_b64_tr_b16 v[198:199], v133 offset:4616
    s_waitcnt lgkmcnt(6)
    v_mfma_f32_16x16x32_bf16 v[64:67], v[184:187], v[136:139], 0
    v_mfma_f32_16x16x32_bf16 v[68:71], v[184:187], v[140:143], 0
    v_mfma_f32_16x16x32_bf16 v[72:75], v[184:187], v[144:147], 0
    v_mfma_f32_16x16x32_bf16 v[76:79], v[184:187], v[148:151], 0
    s_waitcnt lgkmcnt(0)
    s_barrier
    s_lshl_b32 s60, s97, 2
    s_add_u32 s97, s97, 1
    s_cmp_ge_u32 s97, 14
    s_cselect_b32 s97, 0, s97
    v_add_u32 v130, s60, v242
    v_xor_b32 v130, v130, v129
    v_lshlrev_b32 v130, 4, v130
    v_add_u32 v130, v130, v128
    ds_read_b128 v[152:155], v130 offset:0
    ds_read_b128 v[156:159], v130 offset:14336
    ds_read_b128 v[160:163], v130 offset:28672
    ds_read_b128 v[164:167], v130 offset:43008
    ds_read_b64_tr_b16 v[168:169], v132 offset:8192
    ds_read_b64_tr_b16 v[170:171], v132 offset:8704
    v_mfma_f32_16x16x32_bf16 v[80:83], v[188:191], v[136:139], 0
    v_mfma_f32_16x16x32_bf16 v[84:87], v[188:191], v[140:143], 0
    v_mfma_f32_16x16x32_bf16 v[88:91], v[188:191], v[144:147], 0
    v_mfma_f32_16x16x32_bf16 v[92:95], v[188:191], v[148:151], 0
    ds_read_b64_tr_b16 v[172:173], v132 offset:8200
    ds_read_b64_tr_b16 v[174:175], v132 offset:8712
    v_mfma_f32_16x16x32_bf16 v[96:99], v[192:195], v[136:139], 0
    v_mfma_f32_16x16x32_bf16 v[100:103], v[192:195], v[140:143], 0
    v_mfma_f32_16x16x32_bf16 v[104:107], v[192:195], v[144:147], 0
    v_mfma_f32_16x16x32_bf16 v[108:111], v[192:195], v[148:151], 0
    ds_read_b64_tr_b16 v[176:177], v133 offset:8192
    ds_read_b64_tr_b16 v[178:179], v133 offset:8704
    v_mfma_f32_16x16x32_bf16 v[112:115], v[196:199], v[136:139], 0
    v_mfma_f32_16x16x32_bf16 v[116:119], v[196:199], v[140:143], 0
    v_mfma_f32_16x16x32_bf16 v[120:123], v[196:199], v[144:147], 0
    v_mfma_f32_16x16x32_bf16 v[124:127], v[196:199], v[148:151], 0
    ds_read_b64_tr_b16 v[180:181], v133 offset:8200
    ds_read_b64_tr_b16 v[182:183], v133 offset:8712
    s_waitcnt lgkmcnt(6)
    v_mfma_f32_16x16x32_bf16 v[0:3], v[168:171], v[152:155], v[0:3]
    v_mfma_f32_16x16x32_bf16 v[4:7], v[168:171], v[156:159], v[4:7]
    v_mfma_f32_16x16x32_bf16 v[8:11], v[168:171], v[160:163], v[8:11]
    v_mfma_f32_16x16x32_bf16 v[12:15], v[168:171], v[164:167], v[12:15]
    s_waitcnt lgkmcnt(0)
    s_barrier
    ds_read_b64_tr_b16 v[184:185], v132 offset:12288
    ds_read_b64_tr_b16 v[186:187], v132 offset:12800
    v_mfma_f32_16x16x32_bf16 v[16:19], v[172:175], v[152:155], v[16:19]
    v_mfma_f32_16x16x32_bf16 v[20:23], v[172:175], v[156:159], v[20:23]
    v_mfma_f32_16x16x32_bf16 v[24:27], v[172:175], v[160:163], v[24:27]
    v_mfma_f32_16x16x32_bf16 v[28:31], v[172:175], v[164:167], v[28:31]
    ds_read_b64_tr_b16 v[188:189], v132 offset:12296
    ds_read_b64_tr_b16 v[190:191], v132 offset:12808
    v_mfma_f32_16x16x32_bf16 v[32:35], v[176:179], v[152:155], v[32:35]
    v_mfma_f32_16x16x32_bf16 v[36:39], v[176:179], v[156:159], v[36:39]
    v_mfma_f32_16x16x32_bf16 v[40:43], v[176:179], v[160:163], v[40:43]
    v_mfma_f32_16x16x32_bf16 v[44:47], v[176:179], v[164:167], v[44:47]
    ds_read_b64_tr_b16 v[192:193], v133 offset:12288
    ds_read_b64_tr_b16 v[194:195], v133 offset:12800
    v_mfma_f32_16x16x32_bf16 v[48:51], v[180:183], v[152:155], v[48:51]
    v_mfma_f32_16x16x32_bf16 v[52:55], v[180:183], v[156:159], v[52:55]
    v_mfma_f32_16x16x32_bf16 v[56:59], v[180:183], v[160:163], v[56:59]
    v_mfma_f32_16x16x32_bf16 v[60:63], v[180:183], v[164:167], v[60:63]
    ds_read_b64_tr_b16 v[196:197], v133 offset:12296
    ds_read_b64_tr_b16 v[198:199], v133 offset:12808
    s_waitcnt lgkmcnt(6)
    v_mfma_f32_16x16x32_bf16 v[64:67], v[184:187], v[152:155], v[64:67]
    v_mfma_f32_16x16x32_bf16 v[68:71], v[184:187], v[156:159], v[68:71]
    v_mfma_f32_16x16x32_bf16 v[72:75], v[184:187], v[160:163], v[72:75]
    v_mfma_f32_16x16x32_bf16 v[76:79], v[184:187], v[164:167], v[76:79]
    s_waitcnt lgkmcnt(0)
    s_barrier
    s_lshl_b32 s60, s97, 2
    s_add_u32 s97, s97, 1
    s_cmp_ge_u32 s97, 14
    s_cselect_b32 s97, 0, s97
    v_add_u32 v130, s60, v242
    v_xor_b32 v130, v130, v129
    v_lshlrev_b32 v130, 4, v130
    v_add_u32 v130, v130, v128
    ds_read_b128 v[136:139], v130 offset:0
    ds_read_b128 v[140:143], v130 offset:14336
    ds_read_b128 v[144:147], v130 offset:28672
    ds_read_b128 v[148:151], v130 offset:43008
    ds_read_b64_tr_b16 v[168:169], v132 offset:0
    ds_read_b64_tr_b16 v[170:171], v132 offset:512
    v_mfma_f32_16x16x32_bf16 v[80:83], v[188:191], v[152:155], v[80:83]
    v_mfma_f32_16x16x32_bf16 v[84:87], v[188:191], v[156:159], v[84:87]
    v_mfma_f32_16x16x32_bf16 v[88:91], v[188:191], v[160:163], v[88:91]
    v_mfma_f32_16x16x32_bf16 v[92:95], v[188:191], v[164:167], v[92:95]
    ds_read_b64_tr_b16 v[172:173], v132 offset:8
    ds_read_b64_tr_b16 v[174:175], v132 offset:520
    v_mfma_f32_16x16x32_bf16 v[96:99], v[192:195], v[152:155], v[96:99]
    v_mfma_f32_16x16x32_bf16 v[100:103], v[192:195], v[156:159], v[100:103]
    v_mfma_f32_16x16x32_bf16 v[104:107], v[192:195], v[160:163], v[104:107]
    v_mfma_f32_16x16x32_bf16 v[108:111], v[192:195], v[164:167], v[108:111]
    ds_read_b64_tr_b16 v[176:177], v133 offset:0
    ds_read_b64_tr_b16 v[178:179], v133 offset:512
    v_mfma_f32_16x16x32_bf16 v[112:115], v[196:199], v[152:155], v[112:115]
    v_mfma_f32_16x16x32_bf16 v[116:119], v[196:199], v[156:159], v[116:119]
    v_mfma_f32_16x16x32_bf16 v[120:123], v[196:199], v[160:163], v[120:123]
    v_mfma_f32_16x16x32_bf16 v[124:127], v[196:199], v[164:167], v[124:127]
    ds_read_b64_tr_b16 v[180:181], v133 offset:8
    ds_read_b64_tr_b16 v[182:183], v133 offset:520
    s_waitcnt lgkmcnt(6)
    v_mfma_f32_16x16x32_bf16 v[0:3], v[168:171], v[136:139], v[0:3]
    v_mfma_f32_16x16x32_bf16 v[4:7], v[168:171], v[140:143], v[4:7]
    v_mfma_f32_16x16x32_bf16 v[8:11], v[168:171], v[144:147], v[8:11]
    v_mfma_f32_16x16x32_bf16 v[12:15], v[168:171], v[148:151], v[12:15]
    s_waitcnt lgkmcnt(0)
    s_barrier
    ds_read_b64_tr_b16 v[184:185], v132 offset:4096
    ds_read_b64_tr_b16 v[186:187], v132 offset:4608
    v_mfma_f32_16x16x32_bf16 v[16:19], v[172:175], v[136:139], v[16:19]
    v_mfma_f32_16x16x32_bf16 v[20:23], v[172:175], v[140:143], v[20:23]
    v_mfma_f32_16x16x32_bf16 v[24:27], v[172:175], v[144:147], v[24:27]
    v_mfma_f32_16x16x32_bf16 v[28:31], v[172:175], v[148:151], v[28:31]
    ds_read_b64_tr_b16 v[188:189], v132 offset:4104
    ds_read_b64_tr_b16 v[190:191], v132 offset:4616
    v_mfma_f32_16x16x32_bf16 v[32:35], v[176:179], v[136:139], v[32:35]
    v_mfma_f32_16x16x32_bf16 v[36:39], v[176:179], v[140:143], v[36:39]
    v_mfma_f32_16x16x32_bf16 v[40:43], v[176:179], v[144:147], v[40:43]
    v_mfma_f32_16x16x32_bf16 v[44:47], v[176:179], v[148:151], v[44:47]
    ds_read_b64_tr_b16 v[192:193], v133 offset:4096
    ds_read_b64_tr_b16 v[194:195], v133 offset:4608
    v_mfma_f32_16x16x32_bf16 v[48:51], v[180:183], v[136:139], v[48:51]
    v_mfma_f32_16x16x32_bf16 v[52:55], v[180:183], v[140:143], v[52:55]
    v_mfma_f32_16x16x32_bf16 v[56:59], v[180:183], v[144:147], v[56:59]
    v_mfma_f32_16x16x32_bf16 v[60:63], v[180:183], v[148:151], v[60:63]
    ds_read_b64_tr_b16 v[196:197], v133 offset:4104
    ds_read_b64_tr_b16 v[198:199], v133 offset:4616
    s_waitcnt lgkmcnt(6)
    v_mfma_f32_16x16x32_bf16 v[64:67], v[184:187], v[136:139], v[64:67]
    v_mfma_f32_16x16x32_bf16 v[68:71], v[184:187], v[140:143], v[68:71]
    v_mfma_f32_16x16x32_bf16 v[72:75], v[184:187], v[144:147], v[72:75]
    v_mfma_f32_16x16x32_bf16 v[76:79], v[184:187], v[148:151], v[76:79]
    s_waitcnt lgkmcnt(0)
    s_barrier
    s_lshl_b32 s60, s97, 2
    s_add_u32 s97, s97, 1
    s_cmp_ge_u32 s97, 14
    s_cselect_b32 s97, 0, s97
    v_add_u32 v130, s60, v242
    v_xor_b32 v130, v130, v129
    v_lshlrev_b32 v130, 4, v130
    v_add_u32 v130, v130, v128
    ds_read_b128 v[152:155], v130 offset:0
    ds_read_b128 v[156:159], v130 offset:14336
    ds_read_b128 v[160:163], v130 offset:28672
    ds_read_b128 v[164:167], v130 offset:43008
    ds_read_b64_tr_b16 v[168:169], v132 offset:8192
    ds_read_b64_tr_b16 v[170:171], v132 offset:8704
    v_mfma_f32_16x16x32_bf16 v[80:83], v[188:191], v[136:139], v[80:83]
    v_mfma_f32_16x16x32_bf16 v[84:87], v[188:191], v[140:143], v[84:87]
    v_mfma_f32_16x16x32_bf16 v[88:91], v[188:191], v[144:147], v[88:91]
    v_mfma_f32_16x16x32_bf16 v[92:95], v[188:191], v[148:151], v[92:95]
    ds_read_b64_tr_b16 v[172:173], v132 offset:8200
    ds_read_b64_tr_b16 v[174:175], v132 offset:8712
    v_mfma_f32_16x16x32_bf16 v[96:99], v[192:195], v[136:139], v[96:99]
    v_mfma_f32_16x16x32_bf16 v[100:103], v[192:195], v[140:143], v[100:103]
    v_mfma_f32_16x16x32_bf16 v[104:107], v[192:195], v[144:147], v[104:107]
    v_mfma_f32_16x16x32_bf16 v[108:111], v[192:195], v[148:151], v[108:111]
    ds_read_b64_tr_b16 v[176:177], v133 offset:8192
    ds_read_b64_tr_b16 v[178:179], v133 offset:8704
    v_mfma_f32_16x16x32_bf16 v[112:115], v[196:199], v[136:139], v[112:115]
    v_mfma_f32_16x16x32_bf16 v[116:119], v[196:199], v[140:143], v[116:119]
    v_mfma_f32_16x16x32_bf16 v[120:123], v[196:199], v[144:147], v[120:123]
    v_mfma_f32_16x16x32_bf16 v[124:127], v[196:199], v[148:151], v[124:127]
    ds_read_b64_tr_b16 v[180:181], v133 offset:8200
    ds_read_b64_tr_b16 v[182:183], v133 offset:8712
    s_waitcnt lgkmcnt(6)
    v_mfma_f32_16x16x32_bf16 v[0:3], v[168:171], v[152:155], v[0:3]
    v_mfma_f32_16x16x32_bf16 v[4:7], v[168:171], v[156:159], v[4:7]
    v_mfma_f32_16x16x32_bf16 v[8:11], v[168:171], v[160:163], v[8:11]
    v_mfma_f32_16x16x32_bf16 v[12:15], v[168:171], v[164:167], v[12:15]
    s_waitcnt lgkmcnt(0)
    s_barrier
    ds_read_b64_tr_b16 v[184:185], v132 offset:12288
    ds_read_b64_tr_b16 v[186:187], v132 offset:12800
    v_mfma_f32_16x16x32_bf16 v[16:19], v[172:175], v[152:155], v[16:19]
    v_mfma_f32_16x16x32_bf16 v[20:23], v[172:175], v[156:159], v[20:23]
    v_mfma_f32_16x16x32_bf16 v[24:27], v[172:175], v[160:163], v[24:27]
    v_mfma_f32_16x16x32_bf16 v[28:31], v[172:175], v[164:167], v[28:31]
    ds_read_b64_tr_b16 v[188:189], v132 offset:12296
    ds_read_b64_tr_b16 v[190:191], v132 offset:12808
    v_mfma_f32_16x16x32_bf16 v[32:35], v[176:179], v[152:155], v[32:35]
    v_mfma_f32_16x16x32_bf16 v[36:39], v[176:179], v[156:159], v[36:39]
    v_mfma_f32_16x16x32_bf16 v[40:43], v[176:179], v[160:163], v[40:43]
    v_mfma_f32_16x16x32_bf16 v[44:47], v[176:179], v[164:167], v[44:47]
    ds_read_b64_tr_b16 v[192:193], v133 offset:12288
    ds_read_b64_tr_b16 v[194:195], v133 offset:12800
    v_mfma_f32_16x16x32_bf16 v[48:51], v[180:183], v[152:155], v[48:51]
    v_mfma_f32_16x16x32_bf16 v[52:55], v[180:183], v[156:159], v[52:55]
    v_mfma_f32_16x16x32_bf16 v[56:59], v[180:183], v[160:163], v[56:59]
    v_mfma_f32_16x16x32_bf16 v[60:63], v[180:183], v[164:167], v[60:63]
    ds_read_b64_tr_b16 v[196:197], v133 offset:12296
    ds_read_b64_tr_b16 v[198:199], v133 offset:12808
    s_waitcnt lgkmcnt(6)
    v_mfma_f32_16x16x32_bf16 v[64:67], v[184:187], v[152:155], v[64:67]
    v_mfma_f32_16x16x32_bf16 v[68:71], v[184:187], v[156:159], v[68:71]
    v_mfma_f32_16x16x32_bf16 v[72:75], v[184:187], v[160:163], v[72:75]
    v_mfma_f32_16x16x32_bf16 v[76:79], v[184:187], v[164:167], v[76:79]
    s_waitcnt lgkmcnt(0)
    s_barrier
    s_lshl_b32 s60, s97, 2
    s_add_u32 s97, s97, 1
    s_cmp_ge_u32 s97, 14
    s_cselect_b32 s97, 0, s97
    v_add_u32 v130, s60, v242
    v_xor_b32 v130, v130, v129
    v_lshlrev_b32 v130, 4, v130
    v_add_u32 v130, v130, v128
    ds_read_b128 v[136:139], v130 offset:0
    ds_read_b128 v[140:143], v130 offset:14336
    ds_read_b128 v[144:147], v130 offset:28672
    ds_read_b128 v[148:151], v130 offset:43008
    ds_read_b64_tr_b16 v[168:169], v132 offset:0
    ds_read_b64_tr_b16 v[170:171], v132 offset:512
    v_mfma_f32_16x16x32_bf16 v[80:83], v[188:191], v[152:155], v[80:83]
    v_mfma_f32_16x16x32_bf16 v[84:87], v[188:191], v[156:159], v[84:87]
    v_mfma_f32_16x16x32_bf16 v[88:91], v[188:191], v[160:163], v[88:91]
    v_mfma_f32_16x16x32_bf16 v[92:95], v[188:191], v[164:167], v[92:95]
    ds_read_b64_tr_b16 v[172:173], v132 offset:8
    ds_read_b64_tr_b16 v[174:175], v132 offset:520
    v_mfma_f32_16x16x32_bf16 v[96:99], v[192:195], v[152:155], v[96:99]
    v_mfma_f32_16x16x32_bf16 v[100:103], v[192:195], v[156:159], v[100:103]
    v_mfma_f32_16x16x32_bf16 v[104:107], v[192:195], v[160:163], v[104:107]
    v_mfma_f32_16x16x32_bf16 v[108:111], v[192:195], v[164:167], v[108:111]
    ds_read_b64_tr_b16 v[176:177], v133 offset:0
    ds_read_b64_tr_b16 v[178:179], v133 offset:512
    v_mfma_f32_16x16x32_bf16 v[112:115], v[196:199], v[152:155], v[112:115]
    v_mfma_f32_16x16x32_bf16 v[116:119], v[196:199], v[156:159], v[116:119]
    v_mfma_f32_16x16x32_bf16 v[120:123], v[196:199], v[160:163], v[120:123]
    v_mfma_f32_16x16x32_bf16 v[124:127], v[196:199], v[164:167], v[124:127]
    ds_read_b64_tr_b16 v[180:181], v133 offset:8
    ds_read_b64_tr_b16 v[182:183], v133 offset:520
    s_waitcnt lgkmcnt(6)
    v_mfma_f32_16x16x32_bf16 v[0:3], v[168:171], v[136:139], v[0:3]
    v_mfma_f32_16x16x32_bf16 v[4:7], v[168:171], v[140:143], v[4:7]
    v_mfma_f32_16x16x32_bf16 v[8:11], v[168:171], v[144:147], v[8:11]
    v_mfma_f32_16x16x32_bf16 v[12:15], v[168:171], v[148:151], v[12:15]
    s_waitcnt lgkmcnt(0)
    s_barrier
    ds_read_b64_tr_b16 v[184:185], v132 offset:4096
    ds_read_b64_tr_b16 v[186:187], v132 offset:4608
    v_mfma_f32_16x16x32_bf16 v[16:19], v[172:175], v[136:139], v[16:19]
    v_mfma_f32_16x16x32_bf16 v[20:23], v[172:175], v[140:143], v[20:23]
    v_mfma_f32_16x16x32_bf16 v[24:27], v[172:175], v[144:147], v[24:27]
    v_mfma_f32_16x16x32_bf16 v[28:31], v[172:175], v[148:151], v[28:31]
    ds_read_b64_tr_b16 v[188:189], v132 offset:4104
    ds_read_b64_tr_b16 v[190:191], v132 offset:4616
    v_mfma_f32_16x16x32_bf16 v[32:35], v[176:179], v[136:139], v[32:35]
    v_mfma_f32_16x16x32_bf16 v[36:39], v[176:179], v[140:143], v[36:39]
    v_mfma_f32_16x16x32_bf16 v[40:43], v[176:179], v[144:147], v[40:43]
    v_mfma_f32_16x16x32_bf16 v[44:47], v[176:179], v[148:151], v[44:47]
    ds_read_b64_tr_b16 v[192:193], v133 offset:4096
    ds_read_b64_tr_b16 v[194:195], v133 offset:4608
    v_mfma_f32_16x16x32_bf16 v[48:51], v[180:183], v[136:139], v[48:51]
    v_mfma_f32_16x16x32_bf16 v[52:55], v[180:183], v[140:143], v[52:55]
    v_mfma_f32_16x16x32_bf16 v[56:59], v[180:183], v[144:147], v[56:59]
    v_mfma_f32_16x16x32_bf16 v[60:63], v[180:183], v[148:151], v[60:63]
    ds_read_b64_tr_b16 v[196:197], v133 offset:4104
    ds_read_b64_tr_b16 v[198:199], v133 offset:4616
    s_waitcnt lgkmcnt(6)
    v_mfma_f32_16x16x32_bf16 v[64:67], v[184:187], v[136:139], v[64:67]
    v_mfma_f32_16x16x32_bf16 v[68:71], v[184:187], v[140:143], v[68:71]
    v_mfma_f32_16x16x32_bf16 v[72:75], v[184:187], v[144:147], v[72:75]
    v_mfma_f32_16x16x32_bf16 v[76:79], v[184:187], v[148:151], v[76:79]
    s_waitcnt lgkmcnt(0)
    s_barrier
    s_lshl_b32 s60, s97, 2
    s_add_u32 s97, s97, 1
    s_cmp_ge_u32 s97, 14
    s_cselect_b32 s97, 0, s97
    v_add_u32 v130, s60, v242
    v_xor_b32 v130, v130, v129
    v_lshlrev_b32 v130, 4, v130
    v_add_u32 v130, v130, v128
    ds_read_b128 v[152:155], v130 offset:0
    ds_read_b128 v[156:159], v130 offset:14336
    ds_read_b128 v[160:163], v130 offset:28672
    ds_read_b128 v[164:167], v130 offset:43008
    ds_read_b64_tr_b16 v[168:169], v132 offset:8192
    ds_read_b64_tr_b16 v[170:171], v132 offset:8704
    v_mfma_f32_16x16x32_bf16 v[80:83], v[188:191], v[136:139], v[80:83]
    v_mfma_f32_16x16x32_bf16 v[84:87], v[188:191], v[140:143], v[84:87]
    v_mfma_f32_16x16x32_bf16 v[88:91], v[188:191], v[144:147], v[88:91]
    v_mfma_f32_16x16x32_bf16 v[92:95], v[188:191], v[148:151], v[92:95]
    ds_read_b64_tr_b16 v[172:173], v132 offset:8200
    ds_read_b64_tr_b16 v[174:175], v132 offset:8712
    v_mfma_f32_16x16x32_bf16 v[96:99], v[192:195], v[136:139], v[96:99]
    v_mfma_f32_16x16x32_bf16 v[100:103], v[192:195], v[140:143], v[100:103]
    v_mfma_f32_16x16x32_bf16 v[104:107], v[192:195], v[144:147], v[104:107]
    v_mfma_f32_16x16x32_bf16 v[108:111], v[192:195], v[148:151], v[108:111]
    ds_read_b64_tr_b16 v[176:177], v133 offset:8192
    ds_read_b64_tr_b16 v[178:179], v133 offset:8704
    v_mfma_f32_16x16x32_bf16 v[112:115], v[196:199], v[136:139], v[112:115]
    v_mfma_f32_16x16x32_bf16 v[116:119], v[196:199], v[140:143], v[116:119]
    v_mfma_f32_16x16x32_bf16 v[120:123], v[196:199], v[144:147], v[120:123]
    v_mfma_f32_16x16x32_bf16 v[124:127], v[196:199], v[148:151], v[124:127]
    ds_read_b64_tr_b16 v[180:181], v133 offset:8200
    ds_read_b64_tr_b16 v[182:183], v133 offset:8712
    s_waitcnt lgkmcnt(6)
    v_mfma_f32_16x16x32_bf16 v[0:3], v[168:171], v[152:155], v[0:3]
    v_mfma_f32_16x16x32_bf16 v[4:7], v[168:171], v[156:159], v[4:7]
    v_mfma_f32_16x16x32_bf16 v[8:11], v[168:171], v[160:163], v[8:11]
    v_mfma_f32_16x16x32_bf16 v[12:15], v[168:171], v[164:167], v[12:15]
    s_waitcnt lgkmcnt(0)
    s_barrier
    ds_read_b64_tr_b16 v[184:185], v132 offset:12288
    ds_read_b64_tr_b16 v[186:187], v132 offset:12800
    v_mfma_f32_16x16x32_bf16 v[16:19], v[172:175], v[152:155], v[16:19]
    v_mfma_f32_16x16x32_bf16 v[20:23], v[172:175], v[156:159], v[20:23]
    v_mfma_f32_16x16x32_bf16 v[24:27], v[172:175], v[160:163], v[24:27]
    v_mfma_f32_16x16x32_bf16 v[28:31], v[172:175], v[164:167], v[28:31]
    ds_read_b64_tr_b16 v[188:189], v132 offset:12296
    ds_read_b64_tr_b16 v[190:191], v132 offset:12808
    v_mfma_f32_16x16x32_bf16 v[32:35], v[176:179], v[152:155], v[32:35]
    v_mfma_f32_16x16x32_bf16 v[36:39], v[176:179], v[156:159], v[36:39]
    v_mfma_f32_16x16x32_bf16 v[40:43], v[176:179], v[160:163], v[40:43]
    v_mfma_f32_16x16x32_bf16 v[44:47], v[176:179], v[164:167], v[44:47]
    ds_read_b64_tr_b16 v[192:193], v133 offset:12288
    ds_read_b64_tr_b16 v[194:195], v133 offset:12800
    v_mfma_f32_16x16x32_bf16 v[48:51], v[180:183], v[152:155], v[48:51]
    v_mfma_f32_16x16x32_bf16 v[52:55], v[180:183], v[156:159], v[52:55]
    v_mfma_f32_16x16x32_bf16 v[56:59], v[180:183], v[160:163], v[56:59]
    v_mfma_f32_16x16x32_bf16 v[60:63], v[180:183], v[164:167], v[60:63]
    ds_read_b64_tr_b16 v[196:197], v133 offset:12296
    ds_read_b64_tr_b16 v[198:199], v133 offset:12808
    s_waitcnt lgkmcnt(6)
    v_mfma_f32_16x16x32_bf16 v[64:67], v[184:187], v[152:155], v[64:67]
    v_mfma_f32_16x16x32_bf16 v[68:71], v[184:187], v[156:159], v[68:71]
    v_mfma_f32_16x16x32_bf16 v[72:75], v[184:187], v[160:163], v[72:75]
    v_mfma_f32_16x16x32_bf16 v[76:79], v[184:187], v[164:167], v[76:79]
    s_waitcnt lgkmcnt(0)
    s_barrier
    s_lshl_b32 s60, s97, 2
    s_add_u32 s97, s97, 1
    s_cmp_ge_u32 s97, 14
    s_cselect_b32 s97, 0, s97
    v_add_u32 v130, s60, v242
    v_xor_b32 v130, v130, v129
    v_lshlrev_b32 v130, 4, v130
    v_add_u32 v130, v130, v128
    ds_read_b128 v[136:139], v130 offset:0
    ds_read_b128 v[140:143], v130 offset:14336
    ds_read_b128 v[144:147], v130 offset:28672
    ds_read_b128 v[148:151], v130 offset:43008
    ds_read_b64_tr_b16 v[168:169], v132 offset:0
    ds_read_b64_tr_b16 v[170:171], v132 offset:512
    v_mfma_f32_16x16x32_bf16 v[80:83], v[188:191], v[152:155], v[80:83]
    v_mfma_f32_16x16x32_bf16 v[84:87], v[188:191], v[156:159], v[84:87]
    v_mfma_f32_16x16x32_bf16 v[88:91], v[188:191], v[160:163], v[88:91]
    v_mfma_f32_16x16x32_bf16 v[92:95], v[188:191], v[164:167], v[92:95]
    ds_read_b64_tr_b16 v[172:173], v132 offset:8
    ds_read_b64_tr_b16 v[174:175], v132 offset:520
    v_mfma_f32_16x16x32_bf16 v[96:99], v[192:195], v[152:155], v[96:99]
    v_mfma_f32_16x16x32_bf16 v[100:103], v[192:195], v[156:159], v[100:103]
    v_mfma_f32_16x16x32_bf16 v[104:107], v[192:195], v[160:163], v[104:107]
    v_mfma_f32_16x16x32_bf16 v[108:111], v[192:195], v[164:167], v[108:111]
    ds_read_b64_tr_b16 v[176:177], v133 offset:0
    ds_read_b64_tr_b16 v[178:179], v133 offset:512
    v_mfma_f32_16x16x32_bf16 v[112:115], v[196:199], v[152:155], v[112:115]
    v_mfma_f32_16x16x32_bf16 v[116:119], v[196:199], v[156:159], v[116:119]
    v_mfma_f32_16x16x32_bf16 v[120:123], v[196:199], v[160:163], v[120:123]
    v_mfma_f32_16x16x32_bf16 v[124:127], v[196:199], v[164:167], v[124:127]
    ds_read_b64_tr_b16 v[180:181], v133 offset:8
    ds_read_b64_tr_b16 v[182:183], v133 offset:520
    s_waitcnt lgkmcnt(6)
    v_mfma_f32_16x16x32_bf16 v[0:3], v[168:171], v[136:139], v[0:3]
    v_mfma_f32_16x16x32_bf16 v[4:7], v[168:171], v[140:143], v[4:7]
    v_mfma_f32_16x16x32_bf16 v[8:11], v[168:171], v[144:147], v[8:11]
    v_mfma_f32_16x16x32_bf16 v[12:15], v[168:171], v[148:151], v[12:15]
    s_waitcnt lgkmcnt(0)
    s_barrier
    ds_read_b64_tr_b16 v[184:185], v132 offset:4096
    ds_read_b64_tr_b16 v[186:187], v132 offset:4608
    v_mfma_f32_16x16x32_bf16 v[16:19], v[172:175], v[136:139], v[16:19]
    v_mfma_f32_16x16x32_bf16 v[20:23], v[172:175], v[140:143], v[20:23]
    v_mfma_f32_16x16x32_bf16 v[24:27], v[172:175], v[144:147], v[24:27]
    v_mfma_f32_16x16x32_bf16 v[28:31], v[172:175], v[148:151], v[28:31]
    ds_read_b64_tr_b16 v[188:189], v132 offset:4104
    ds_read_b64_tr_b16 v[190:191], v132 offset:4616
    v_mfma_f32_16x16x32_bf16 v[32:35], v[176:179], v[136:139], v[32:35]
    v_mfma_f32_16x16x32_bf16 v[36:39], v[176:179], v[140:143], v[36:39]
    v_mfma_f32_16x16x32_bf16 v[40:43], v[176:179], v[144:147], v[40:43]
    v_mfma_f32_16x16x32_bf16 v[44:47], v[176:179], v[148:151], v[44:47]
    ds_read_b64_tr_b16 v[192:193], v133 offset:4096
    ds_read_b64_tr_b16 v[194:195], v133 offset:4608
    v_mfma_f32_16x16x32_bf16 v[48:51], v[180:183], v[136:139], v[48:51]
    v_mfma_f32_16x16x32_bf16 v[52:55], v[180:183], v[140:143], v[52:55]
    v_mfma_f32_16x16x32_bf16 v[56:59], v[180:183], v[144:147], v[56:59]
    v_mfma_f32_16x16x32_bf16 v[60:63], v[180:183], v[148:151], v[60:63]
    ds_read_b64_tr_b16 v[196:197], v133 offset:4104
    ds_read_b64_tr_b16 v[198:199], v133 offset:4616
    s_waitcnt lgkmcnt(6)
    v_mfma_f32_16x16x32_bf16 v[64:67], v[184:187], v[136:139], v[64:67]
    v_mfma_f32_16x16x32_bf16 v[68:71], v[184:187], v[140:143], v[68:71]
    v_mfma_f32_16x16x32_bf16 v[72:75], v[184:187], v[144:147], v[72:75]
    v_mfma_f32_16x16x32_bf16 v[76:79], v[184:187], v[148:151], v[76:79]
    s_waitcnt lgkmcnt(0)
    s_barrier
    s_lshl_b32 s60, s97, 2
    s_add_u32 s97, s97, 1
    s_cmp_ge_u32 s97, 14
    s_cselect_b32 s97, 0, s97
    v_add_u32 v130, s60, v242
    v_xor_b32 v130, v130, v129
    v_lshlrev_b32 v130, 4, v130
    v_add_u32 v130, v130, v128
    ds_read_b128 v[152:155], v130 offset:0
    ds_read_b128 v[156:159], v130 offset:14336
    ds_read_b128 v[160:163], v130 offset:28672
    ds_read_b128 v[164:167], v130 offset:43008
    ds_read_b64_tr_b16 v[168:169], v132 offset:8192
    ds_read_b64_tr_b16 v[170:171], v132 offset:8704
    v_mfma_f32_16x16x32_bf16 v[80:83], v[188:191], v[136:139], v[80:83]
    v_mfma_f32_16x16x32_bf16 v[84:87], v[188:191], v[140:143], v[84:87]
    v_mfma_f32_16x16x32_bf16 v[88:91], v[188:191], v[144:147], v[88:91]
    v_mfma_f32_16x16x32_bf16 v[92:95], v[188:191], v[148:151], v[92:95]
    ds_read_b64_tr_b16 v[172:173], v132 offset:8200
    ds_read_b64_tr_b16 v[174:175], v132 offset:8712
    v_mfma_f32_16x16x32_bf16 v[96:99], v[192:195], v[136:139], v[96:99]
    v_mfma_f32_16x16x32_bf16 v[100:103], v[192:195], v[140:143], v[100:103]
    v_mfma_f32_16x16x32_bf16 v[104:107], v[192:195], v[144:147], v[104:107]
    v_mfma_f32_16x16x32_bf16 v[108:111], v[192:195], v[148:151], v[108:111]
    ds_read_b64_tr_b16 v[176:177], v133 offset:8192
    ds_read_b64_tr_b16 v[178:179], v133 offset:8704
    v_mfma_f32_16x16x32_bf16 v[112:115], v[196:199], v[136:139], v[112:115]
    v_mfma_f32_16x16x32_bf16 v[116:119], v[196:199], v[140:143], v[116:119]
    v_mfma_f32_16x16x32_bf16 v[120:123], v[196:199], v[144:147], v[120:123]
    v_mfma_f32_16x16x32_bf16 v[124:127], v[196:199], v[148:151], v[124:127]
    ds_read_b64_tr_b16 v[180:181], v133 offset:8200
    ds_read_b64_tr_b16 v[182:183], v133 offset:8712
    s_waitcnt lgkmcnt(6)
    v_mfma_f32_16x16x32_bf16 v[0:3], v[168:171], v[152:155], v[0:3]
    v_mfma_f32_16x16x32_bf16 v[4:7], v[168:171], v[156:159], v[4:7]
    v_mfma_f32_16x16x32_bf16 v[8:11], v[168:171], v[160:163], v[8:11]
    v_mfma_f32_16x16x32_bf16 v[12:15], v[168:171], v[164:167], v[12:15]
    s_waitcnt lgkmcnt(0)
    s_barrier
    ds_read_b64_tr_b16 v[184:185], v132 offset:12288
    ds_read_b64_tr_b16 v[186:187], v132 offset:12800
    v_mfma_f32_16x16x32_bf16 v[16:19], v[172:175], v[152:155], v[16:19]
    v_mfma_f32_16x16x32_bf16 v[20:23], v[172:175], v[156:159], v[20:23]
    v_mfma_f32_16x16x32_bf16 v[24:27], v[172:175], v[160:163], v[24:27]
    v_mfma_f32_16x16x32_bf16 v[28:31], v[172:175], v[164:167], v[28:31]
    ds_read_b64_tr_b16 v[188:189], v132 offset:12296
    ds_read_b64_tr_b16 v[190:191], v132 offset:12808
    v_mfma_f32_16x16x32_bf16 v[32:35], v[176:179], v[152:155], v[32:35]
    v_mfma_f32_16x16x32_bf16 v[36:39], v[176:179], v[156:159], v[36:39]
    v_mfma_f32_16x16x32_bf16 v[40:43], v[176:179], v[160:163], v[40:43]
    v_mfma_f32_16x16x32_bf16 v[44:47], v[176:179], v[164:167], v[44:47]
    ds_read_b64_tr_b16 v[192:193], v133 offset:12288
    ds_read_b64_tr_b16 v[194:195], v133 offset:12800
    v_mfma_f32_16x16x32_bf16 v[48:51], v[180:183], v[152:155], v[48:51]
    v_mfma_f32_16x16x32_bf16 v[52:55], v[180:183], v[156:159], v[52:55]
    v_mfma_f32_16x16x32_bf16 v[56:59], v[180:183], v[160:163], v[56:59]
    v_mfma_f32_16x16x32_bf16 v[60:63], v[180:183], v[164:167], v[60:63]
    ds_read_b64_tr_b16 v[196:197], v133 offset:12296
    ds_read_b64_tr_b16 v[198:199], v133 offset:12808
    s_waitcnt lgkmcnt(6)
    v_mfma_f32_16x16x32_bf16 v[64:67], v[184:187], v[152:155], v[64:67]
    v_mfma_f32_16x16x32_bf16 v[68:71], v[184:187], v[156:159], v[68:71]
    v_mfma_f32_16x16x32_bf16 v[72:75], v[184:187], v[160:163], v[72:75]
    v_mfma_f32_16x16x32_bf16 v[76:79], v[184:187], v[164:167], v[76:79]
    s_waitcnt lgkmcnt(0)
    s_barrier
    s_lshl_b32 s60, s97, 2
    s_add_u32 s97, s97, 1
    s_cmp_ge_u32 s97, 14
    s_cselect_b32 s97, 0, s97
    v_add_u32 v130, s60, v242
    v_xor_b32 v130, v130, v129
    v_lshlrev_b32 v130, 4, v130
    v_add_u32 v130, v130, v128
    ds_read_b128 v[136:139], v130 offset:0
    ds_read_b128 v[140:143], v130 offset:14336
    ds_read_b128 v[144:147], v130 offset:28672
    ds_read_b128 v[148:151], v130 offset:43008
    ds_read_b64_tr_b16 v[168:169], v132 offset:0
    ds_read_b64_tr_b16 v[170:171], v132 offset:512
    v_mfma_f32_16x16x32_bf16 v[80:83], v[188:191], v[152:155], v[80:83]
    v_mfma_f32_16x16x32_bf16 v[84:87], v[188:191], v[156:159], v[84:87]
    v_mfma_f32_16x16x32_bf16 v[88:91], v[188:191], v[160:163], v[88:91]
    v_mfma_f32_16x16x32_bf16 v[92:95], v[188:191], v[164:167], v[92:95]
    ds_read_b64_tr_b16 v[172:173], v132 offset:8
    ds_read_b64_tr_b16 v[174:175], v132 offset:520
    v_mfma_f32_16x16x32_bf16 v[96:99], v[192:195], v[152:155], v[96:99]
    v_mfma_f32_16x16x32_bf16 v[100:103], v[192:195], v[156:159], v[100:103]
    v_mfma_f32_16x16x32_bf16 v[104:107], v[192:195], v[160:163], v[104:107]
    v_mfma_f32_16x16x32_bf16 v[108:111], v[192:195], v[164:167], v[108:111]
    ds_read_b64_tr_b16 v[176:177], v133 offset:0
    ds_read_b64_tr_b16 v[178:179], v133 offset:512
    v_mfma_f32_16x16x32_bf16 v[112:115], v[196:199], v[152:155], v[112:115]
    v_mfma_f32_16x16x32_bf16 v[116:119], v[196:199], v[156:159], v[116:119]
    v_mfma_f32_16x16x32_bf16 v[120:123], v[196:199], v[160:163], v[120:123]
    v_mfma_f32_16x16x32_bf16 v[124:127], v[196:199], v[164:167], v[124:127]
    ds_read_b64_tr_b16 v[180:181], v133 offset:8
    ds_read_b64_tr_b16 v[182:183], v133 offset:520
    s_waitcnt lgkmcnt(6)
    v_mfma_f32_16x16x32_bf16 v[0:3], v[168:171], v[136:139], v[0:3]
    v_mfma_f32_16x16x32_bf16 v[4:7], v[168:171], v[140:143], v[4:7]
    v_mfma_f32_16x16x32_bf16 v[8:11], v[168:171], v[144:147], v[8:11]
    v_mfma_f32_16x16x32_bf16 v[12:15], v[168:171], v[148:151], v[12:15]
    s_waitcnt lgkmcnt(0)
    s_barrier
    ds_read_b64_tr_b16 v[184:185], v132 offset:4096
    ds_read_b64_tr_b16 v[186:187], v132 offset:4608
    v_mfma_f32_16x16x32_bf16 v[16:19], v[172:175], v[136:139], v[16:19]
    v_mfma_f32_16x16x32_bf16 v[20:23], v[172:175], v[140:143], v[20:23]
    v_mfma_f32_16x16x32_bf16 v[24:27], v[172:175], v[144:147], v[24:27]
    v_mfma_f32_16x16x32_bf16 v[28:31], v[172:175], v[148:151], v[28:31]
    ds_read_b64_tr_b16 v[188:189], v132 offset:4104
    ds_read_b64_tr_b16 v[190:191], v132 offset:4616
    v_mfma_f32_16x16x32_bf16 v[32:35], v[176:179], v[136:139], v[32:35]
    v_mfma_f32_16x16x32_bf16 v[36:39], v[176:179], v[140:143], v[36:39]
    v_mfma_f32_16x16x32_bf16 v[40:43], v[176:179], v[144:147], v[40:43]
    v_mfma_f32_16x16x32_bf16 v[44:47], v[176:179], v[148:151], v[44:47]
    ds_read_b64_tr_b16 v[192:193], v133 offset:4096
    ds_read_b64_tr_b16 v[194:195], v133 offset:4608
    v_mfma_f32_16x16x32_bf16 v[48:51], v[180:183], v[136:139], v[48:51]
    v_mfma_f32_16x16x32_bf16 v[52:55], v[180:183], v[140:143], v[52:55]
    v_mfma_f32_16x16x32_bf16 v[56:59], v[180:183], v[144:147], v[56:59]
    v_mfma_f32_16x16x32_bf16 v[60:63], v[180:183], v[148:151], v[60:63]
    ds_read_b64_tr_b16 v[196:197], v133 offset:4104
    ds_read_b64_tr_b16 v[198:199], v133 offset:4616
    s_waitcnt lgkmcnt(6)
    v_mfma_f32_16x16x32_bf16 v[64:67], v[184:187], v[136:139], v[64:67]
    v_mfma_f32_16x16x32_bf16 v[68:71], v[184:187], v[140:143], v[68:71]
    v_mfma_f32_16x16x32_bf16 v[72:75], v[184:187], v[144:147], v[72:75]
    v_mfma_f32_16x16x32_bf16 v[76:79], v[184:187], v[148:151], v[76:79]
    s_waitcnt lgkmcnt(0)
    s_barrier
    s_lshl_b32 s60, s97, 2
    s_add_u32 s97, s97, 1
    s_cmp_ge_u32 s97, 14
    s_cselect_b32 s97, 0, s97
    v_add_u32 v130, s60, v242
    v_xor_b32 v130, v130, v129
    v_lshlrev_b32 v130, 4, v130
    v_add_u32 v130, v130, v128
    ds_read_b128 v[152:155], v130 offset:0
    ds_read_b128 v[156:159], v130 offset:14336
    ds_read_b128 v[160:163], v130 offset:28672
    ds_read_b128 v[164:167], v130 offset:43008
    ds_read_b64_tr_b16 v[168:169], v132 offset:8192
    ds_read_b64_tr_b16 v[170:171], v132 offset:8704
    v_mfma_f32_16x16x32_bf16 v[80:83], v[188:191], v[136:139], v[80:83]
    v_mfma_f32_16x16x32_bf16 v[84:87], v[188:191], v[140:143], v[84:87]
    v_mfma_f32_16x16x32_bf16 v[88:91], v[188:191], v[144:147], v[88:91]
    v_mfma_f32_16x16x32_bf16 v[92:95], v[188:191], v[148:151], v[92:95]
    ds_read_b64_tr_b16 v[172:173], v132 offset:8200
    ds_read_b64_tr_b16 v[174:175], v132 offset:8712
    v_mfma_f32_16x16x32_bf16 v[96:99], v[192:195], v[136:139], v[96:99]
    v_mfma_f32_16x16x32_bf16 v[100:103], v[192:195], v[140:143], v[100:103]
    v_mfma_f32_16x16x32_bf16 v[104:107], v[192:195], v[144:147], v[104:107]
    v_mfma_f32_16x16x32_bf16 v[108:111], v[192:195], v[148:151], v[108:111]
    ds_read_b64_tr_b16 v[176:177], v133 offset:8192
    ds_read_b64_tr_b16 v[178:179], v133 offset:8704
    v_mfma_f32_16x16x32_bf16 v[112:115], v[196:199], v[136:139], v[112:115]
    v_mfma_f32_16x16x32_bf16 v[116:119], v[196:199], v[140:143], v[116:119]
    v_mfma_f32_16x16x32_bf16 v[120:123], v[196:199], v[144:147], v[120:123]
    v_mfma_f32_16x16x32_bf16 v[124:127], v[196:199], v[148:151], v[124:127]
    ds_read_b64_tr_b16 v[180:181], v133 offset:8200
    ds_read_b64_tr_b16 v[182:183], v133 offset:8712
    s_waitcnt lgkmcnt(6)
    v_mfma_f32_16x16x32_bf16 v[0:3], v[168:171], v[152:155], v[0:3]
    v_mfma_f32_16x16x32_bf16 v[4:7], v[168:171], v[156:159], v[4:7]
    v_mfma_f32_16x16x32_bf16 v[8:11], v[168:171], v[160:163], v[8:11]
    v_mfma_f32_16x16x32_bf16 v[12:15], v[168:171], v[164:167], v[12:15]
    s_waitcnt lgkmcnt(0)
    s_barrier
    ds_read_b64_tr_b16 v[184:185], v132 offset:12288
    ds_read_b64_tr_b16 v[186:187], v132 offset:12800
    v_mfma_f32_16x16x32_bf16 v[16:19], v[172:175], v[152:155], v[16:19]
    v_mfma_f32_16x16x32_bf16 v[20:23], v[172:175], v[156:159], v[20:23]
    v_mfma_f32_16x16x32_bf16 v[24:27], v[172:175], v[160:163], v[24:27]
    v_mfma_f32_16x16x32_bf16 v[28:31], v[172:175], v[164:167], v[28:31]
    ds_read_b64_tr_b16 v[188:189], v132 offset:12296
    ds_read_b64_tr_b16 v[190:191], v132 offset:12808
    v_mfma_f32_16x16x32_bf16 v[32:35], v[176:179], v[152:155], v[32:35]
    v_mfma_f32_16x16x32_bf16 v[36:39], v[176:179], v[156:159], v[36:39]
    v_mfma_f32_16x16x32_bf16 v[40:43], v[176:179], v[160:163], v[40:43]
    v_mfma_f32_16x16x32_bf16 v[44:47], v[176:179], v[164:167], v[44:47]
    ds_read_b64_tr_b16 v[192:193], v133 offset:12288
    ds_read_b64_tr_b16 v[194:195], v133 offset:12800
    v_mfma_f32_16x16x32_bf16 v[48:51], v[180:183], v[152:155], v[48:51]
    v_mfma_f32_16x16x32_bf16 v[52:55], v[180:183], v[156:159], v[52:55]
    v_mfma_f32_16x16x32_bf16 v[56:59], v[180:183], v[160:163], v[56:59]
    v_mfma_f32_16x16x32_bf16 v[60:63], v[180:183], v[164:167], v[60:63]
    ds_read_b64_tr_b16 v[196:197], v133 offset:12296
    ds_read_b64_tr_b16 v[198:199], v133 offset:12808
    s_waitcnt lgkmcnt(6)
    v_mfma_f32_16x16x32_bf16 v[64:67], v[184:187], v[152:155], v[64:67]
    v_mfma_f32_16x16x32_bf16 v[68:71], v[184:187], v[156:159], v[68:71]
    v_mfma_f32_16x16x32_bf16 v[72:75], v[184:187], v[160:163], v[72:75]
    v_mfma_f32_16x16x32_bf16 v[76:79], v[184:187], v[164:167], v[76:79]
    s_waitcnt lgkmcnt(0)
    s_barrier
    s_lshl_b32 s60, s97, 2
    s_add_u32 s97, s97, 1
    s_cmp_ge_u32 s97, 14
    s_cselect_b32 s97, 0, s97
    v_add_u32 v130, s60, v242
    v_xor_b32 v130, v130, v129
    v_lshlrev_b32 v130, 4, v130
    v_add_u32 v130, v130, v128
    ds_read_b128 v[136:139], v130 offset:0
    ds_read_b128 v[140:143], v130 offset:14336
    ds_read_b128 v[144:147], v130 offset:28672
    ds_read_b128 v[148:151], v130 offset:43008
    ds_read_b64_tr_b16 v[168:169], v132 offset:0
    ds_read_b64_tr_b16 v[170:171], v132 offset:512
    v_mfma_f32_16x16x32_bf16 v[80:83], v[188:191], v[152:155], v[80:83]
    v_mfma_f32_16x16x32_bf16 v[84:87], v[188:191], v[156:159], v[84:87]
    v_mfma_f32_16x16x32_bf16 v[88:91], v[188:191], v[160:163], v[88:91]
    v_mfma_f32_16x16x32_bf16 v[92:95], v[188:191], v[164:167], v[92:95]
    ds_read_b64_tr_b16 v[172:173], v132 offset:8
    ds_read_b64_tr_b16 v[174:175], v132 offset:520
    v_mfma_f32_16x16x32_bf16 v[96:99], v[192:195], v[152:155], v[96:99]
    v_mfma_f32_16x16x32_bf16 v[100:103], v[192:195], v[156:159], v[100:103]
    v_mfma_f32_16x16x32_bf16 v[104:107], v[192:195], v[160:163], v[104:107]
    v_mfma_f32_16x16x32_bf16 v[108:111], v[192:195], v[164:167], v[108:111]
    ds_read_b64_tr_b16 v[176:177], v133 offset:0
    ds_read_b64_tr_b16 v[178:179], v133 offset:512
    v_mfma_f32_16x16x32_bf16 v[112:115], v[196:199], v[152:155], v[112:115]
    v_mfma_f32_16x16x32_bf16 v[116:119], v[196:199], v[156:159], v[116:119]
    v_mfma_f32_16x16x32_bf16 v[120:123], v[196:199], v[160:163], v[120:123]
    v_mfma_f32_16x16x32_bf16 v[124:127], v[196:199], v[164:167], v[124:127]
    ds_read_b64_tr_b16 v[180:181], v133 offset:8
    ds_read_b64_tr_b16 v[182:183], v133 offset:520
    s_waitcnt lgkmcnt(6)
    v_mfma_f32_16x16x32_bf16 v[0:3], v[168:171], v[136:139], v[0:3]
    v_mfma_f32_16x16x32_bf16 v[4:7], v[168:171], v[140:143], v[4:7]
    v_mfma_f32_16x16x32_bf16 v[8:11], v[168:171], v[144:147], v[8:11]
    v_mfma_f32_16x16x32_bf16 v[12:15], v[168:171], v[148:151], v[12:15]
    s_waitcnt lgkmcnt(0)
    s_barrier
    ds_read_b64_tr_b16 v[184:185], v132 offset:4096
    ds_read_b64_tr_b16 v[186:187], v132 offset:4608
    v_mfma_f32_16x16x32_bf16 v[16:19], v[172:175], v[136:139], v[16:19]
    v_mfma_f32_16x16x32_bf16 v[20:23], v[172:175], v[140:143], v[20:23]
    v_mfma_f32_16x16x32_bf16 v[24:27], v[172:175], v[144:147], v[24:27]
    v_mfma_f32_16x16x32_bf16 v[28:31], v[172:175], v[148:151], v[28:31]
    ds_read_b64_tr_b16 v[188:189], v132 offset:4104
    ds_read_b64_tr_b16 v[190:191], v132 offset:4616
    v_mfma_f32_16x16x32_bf16 v[32:35], v[176:179], v[136:139], v[32:35]
    v_mfma_f32_16x16x32_bf16 v[36:39], v[176:179], v[140:143], v[36:39]
    v_mfma_f32_16x16x32_bf16 v[40:43], v[176:179], v[144:147], v[40:43]
    v_mfma_f32_16x16x32_bf16 v[44:47], v[176:179], v[148:151], v[44:47]
    ds_read_b64_tr_b16 v[192:193], v133 offset:4096
    ds_read_b64_tr_b16 v[194:195], v133 offset:4608
    v_mfma_f32_16x16x32_bf16 v[48:51], v[180:183], v[136:139], v[48:51]
    v_mfma_f32_16x16x32_bf16 v[52:55], v[180:183], v[140:143], v[52:55]
    v_mfma_f32_16x16x32_bf16 v[56:59], v[180:183], v[144:147], v[56:59]
    v_mfma_f32_16x16x32_bf16 v[60:63], v[180:183], v[148:151], v[60:63]
    ds_read_b64_tr_b16 v[196:197], v133 offset:4104
    ds_read_b64_tr_b16 v[198:199], v133 offset:4616
    s_waitcnt lgkmcnt(6)
    v_mfma_f32_16x16x32_bf16 v[64:67], v[184:187], v[136:139], v[64:67]
    v_mfma_f32_16x16x32_bf16 v[68:71], v[184:187], v[140:143], v[68:71]
    v_mfma_f32_16x16x32_bf16 v[72:75], v[184:187], v[144:147], v[72:75]
    v_mfma_f32_16x16x32_bf16 v[76:79], v[184:187], v[148:151], v[76:79]
    s_waitcnt lgkmcnt(0)
    s_barrier
    s_lshl_b32 s60, s97, 2
    s_add_u32 s97, s97, 1
    s_cmp_ge_u32 s97, 14
    s_cselect_b32 s97, 0, s97
    v_add_u32 v130, s60, v242
    v_xor_b32 v130, v130, v129
    v_lshlrev_b32 v130, 4, v130
    v_add_u32 v130, v130, v128
    ds_read_b128 v[152:155], v130 offset:0
    ds_read_b128 v[156:159], v130 offset:14336
    ds_read_b128 v[160:163], v130 offset:28672
    ds_read_b128 v[164:167], v130 offset:43008
    ds_read_b64_tr_b16 v[168:169], v132 offset:8192
    ds_read_b64_tr_b16 v[170:171], v132 offset:8704
    v_mfma_f32_16x16x32_bf16 v[80:83], v[188:191], v[136:139], v[80:83]
    v_mfma_f32_16x16x32_bf16 v[84:87], v[188:191], v[140:143], v[84:87]
    v_mfma_f32_16x16x32_bf16 v[88:91], v[188:191], v[144:147], v[88:91]
    v_mfma_f32_16x16x32_bf16 v[92:95], v[188:191], v[148:151], v[92:95]
    ds_read_b64_tr_b16 v[172:173], v132 offset:8200
    ds_read_b64_tr_b16 v[174:175], v132 offset:8712
    v_mfma_f32_16x16x32_bf16 v[96:99], v[192:195], v[136:139], v[96:99]
    v_mfma_f32_16x16x32_bf16 v[100:103], v[192:195], v[140:143], v[100:103]
    v_mfma_f32_16x16x32_bf16 v[104:107], v[192:195], v[144:147], v[104:107]
    v_mfma_f32_16x16x32_bf16 v[108:111], v[192:195], v[148:151], v[108:111]
    ds_read_b64_tr_b16 v[176:177], v133 offset:8192
    ds_read_b64_tr_b16 v[178:179], v133 offset:8704
    v_mfma_f32_16x16x32_bf16 v[112:115], v[196:199], v[136:139], v[112:115]
    v_mfma_f32_16x16x32_bf16 v[116:119], v[196:199], v[140:143], v[116:119]
    v_mfma_f32_16x16x32_bf16 v[120:123], v[196:199], v[144:147], v[120:123]
    v_mfma_f32_16x16x32_bf16 v[124:127], v[196:199], v[148:151], v[124:127]
    ds_read_b64_tr_b16 v[180:181], v133 offset:8200
    ds_read_b64_tr_b16 v[182:183], v133 offset:8712
    s_waitcnt lgkmcnt(6)
    v_mfma_f32_16x16x32_bf16 v[0:3], v[168:171], v[152:155], v[0:3]
    v_mfma_f32_16x16x32_bf16 v[4:7], v[168:171], v[156:159], v[4:7]
    v_mfma_f32_16x16x32_bf16 v[8:11], v[168:171], v[160:163], v[8:11]
    v_mfma_f32_16x16x32_bf16 v[12:15], v[168:171], v[164:167], v[12:15]
    s_waitcnt lgkmcnt(0)
    s_barrier
    ds_read_b64_tr_b16 v[184:185], v132 offset:12288
    ds_read_b64_tr_b16 v[186:187], v132 offset:12800
    v_mfma_f32_16x16x32_bf16 v[16:19], v[172:175], v[152:155], v[16:19]
    v_mfma_f32_16x16x32_bf16 v[20:23], v[172:175], v[156:159], v[20:23]
    v_mfma_f32_16x16x32_bf16 v[24:27], v[172:175], v[160:163], v[24:27]
    v_mfma_f32_16x16x32_bf16 v[28:31], v[172:175], v[164:167], v[28:31]
    ds_read_b64_tr_b16 v[188:189], v132 offset:12296
    ds_read_b64_tr_b16 v[190:191], v132 offset:12808
    v_mfma_f32_16x16x32_bf16 v[32:35], v[176:179], v[152:155], v[32:35]
    v_mfma_f32_16x16x32_bf16 v[36:39], v[176:179], v[156:159], v[36:39]
    v_mfma_f32_16x16x32_bf16 v[40:43], v[176:179], v[160:163], v[40:43]
    v_mfma_f32_16x16x32_bf16 v[44:47], v[176:179], v[164:167], v[44:47]
    ds_read_b64_tr_b16 v[192:193], v133 offset:12288
    ds_read_b64_tr_b16 v[194:195], v133 offset:12800
    v_mfma_f32_16x16x32_bf16 v[48:51], v[180:183], v[152:155], v[48:51]
    v_mfma_f32_16x16x32_bf16 v[52:55], v[180:183], v[156:159], v[52:55]
    v_mfma_f32_16x16x32_bf16 v[56:59], v[180:183], v[160:163], v[56:59]
    v_mfma_f32_16x16x32_bf16 v[60:63], v[180:183], v[164:167], v[60:63]
    ds_read_b64_tr_b16 v[196:197], v133 offset:12296
    ds_read_b64_tr_b16 v[198:199], v133 offset:12808
    s_waitcnt lgkmcnt(6)
    v_mfma_f32_16x16x32_bf16 v[64:67], v[184:187], v[152:155], v[64:67]
    v_mfma_f32_16x16x32_bf16 v[68:71], v[184:187], v[156:159], v[68:71]
    v_mfma_f32_16x16x32_bf16 v[72:75], v[184:187], v[160:163], v[72:75]
    v_mfma_f32_16x16x32_bf16 v[76:79], v[184:187], v[164:167], v[76:79]
    s_waitcnt lgkmcnt(0)
    s_barrier
    s_lshl_b32 s60, s97, 2
    s_add_u32 s97, s97, 1
    s_cmp_ge_u32 s97, 14
    s_cselect_b32 s97, 0, s97
    v_add_u32 v130, s60, v242
    v_xor_b32 v130, v130, v129
    v_lshlrev_b32 v130, 4, v130
    v_add_u32 v130, v130, v128
    ds_read_b128 v[136:139], v130 offset:0
    ds_read_b128 v[140:143], v130 offset:14336
    ds_read_b128 v[144:147], v130 offset:28672
    ds_read_b128 v[148:151], v130 offset:43008
    ds_read_b64_tr_b16 v[168:169], v132 offset:0
    ds_read_b64_tr_b16 v[170:171], v132 offset:512
    v_mfma_f32_16x16x32_bf16 v[80:83], v[188:191], v[152:155], v[80:83]
    v_mfma_f32_16x16x32_bf16 v[84:87], v[188:191], v[156:159], v[84:87]
    v_mfma_f32_16x16x32_bf16 v[88:91], v[188:191], v[160:163], v[88:91]
    v_mfma_f32_16x16x32_bf16 v[92:95], v[188:191], v[164:167], v[92:95]
    ds_read_b64_tr_b16 v[172:173], v132 offset:8
    ds_read_b64_tr_b16 v[174:175], v132 offset:520
    v_mfma_f32_16x16x32_bf16 v[96:99], v[192:195], v[152:155], v[96:99]
    v_mfma_f32_16x16x32_bf16 v[100:103], v[192:195], v[156:159], v[100:103]
    v_mfma_f32_16x16x32_bf16 v[104:107], v[192:195], v[160:163], v[104:107]
    v_mfma_f32_16x16x32_bf16 v[108:111], v[192:195], v[164:167], v[108:111]
    ds_read_b64_tr_b16 v[176:177], v133 offset:0
    ds_read_b64_tr_b16 v[178:179], v133 offset:512
    v_mfma_f32_16x16x32_bf16 v[112:115], v[196:199], v[152:155], v[112:115]
    v_mfma_f32_16x16x32_bf16 v[116:119], v[196:199], v[156:159], v[116:119]
    v_mfma_f32_16x16x32_bf16 v[120:123], v[196:199], v[160:163], v[120:123]
    v_mfma_f32_16x16x32_bf16 v[124:127], v[196:199], v[164:167], v[124:127]
    ds_read_b64_tr_b16 v[180:181], v133 offset:8
    ds_read_b64_tr_b16 v[182:183], v133 offset:520
    s_waitcnt lgkmcnt(6)
    v_mfma_f32_16x16x32_bf16 v[0:3], v[168:171], v[136:139], v[0:3]
    v_mfma_f32_16x16x32_bf16 v[4:7], v[168:171], v[140:143], v[4:7]
    v_mfma_f32_16x16x32_bf16 v[8:11], v[168:171], v[144:147], v[8:11]
    v_mfma_f32_16x16x32_bf16 v[12:15], v[168:171], v[148:151], v[12:15]
    s_waitcnt lgkmcnt(0)
    s_barrier
    ds_read_b64_tr_b16 v[184:185], v132 offset:4096
    ds_read_b64_tr_b16 v[186:187], v132 offset:4608
    v_mfma_f32_16x16x32_bf16 v[16:19], v[172:175], v[136:139], v[16:19]
    v_mfma_f32_16x16x32_bf16 v[20:23], v[172:175], v[140:143], v[20:23]
    v_mfma_f32_16x16x32_bf16 v[24:27], v[172:175], v[144:147], v[24:27]
    v_mfma_f32_16x16x32_bf16 v[28:31], v[172:175], v[148:151], v[28:31]
    ds_read_b64_tr_b16 v[188:189], v132 offset:4104
    ds_read_b64_tr_b16 v[190:191], v132 offset:4616
    v_mfma_f32_16x16x32_bf16 v[32:35], v[176:179], v[136:139], v[32:35]
    v_mfma_f32_16x16x32_bf16 v[36:39], v[176:179], v[140:143], v[36:39]
    v_mfma_f32_16x16x32_bf16 v[40:43], v[176:179], v[144:147], v[40:43]
    v_mfma_f32_16x16x32_bf16 v[44:47], v[176:179], v[148:151], v[44:47]
    ds_read_b64_tr_b16 v[192:193], v133 offset:4096
    ds_read_b64_tr_b16 v[194:195], v133 offset:4608
    v_mfma_f32_16x16x32_bf16 v[48:51], v[180:183], v[136:139], v[48:51]
    v_mfma_f32_16x16x32_bf16 v[52:55], v[180:183], v[140:143], v[52:55]
    v_mfma_f32_16x16x32_bf16 v[56:59], v[180:183], v[144:147], v[56:59]
    v_mfma_f32_16x16x32_bf16 v[60:63], v[180:183], v[148:151], v[60:63]
    ds_read_b64_tr_b16 v[196:197], v133 offset:4104
    ds_read_b64_tr_b16 v[198:199], v133 offset:4616
    s_waitcnt lgkmcnt(6)
    v_mfma_f32_16x16x32_bf16 v[64:67], v[184:187], v[136:139], v[64:67]
    v_mfma_f32_16x16x32_bf16 v[68:71], v[184:187], v[140:143], v[68:71]
    v_mfma_f32_16x16x32_bf16 v[72:75], v[184:187], v[144:147], v[72:75]
    v_mfma_f32_16x16x32_bf16 v[76:79], v[184:187], v[148:151], v[76:79]
    s_waitcnt lgkmcnt(0)
    s_barrier
    s_lshl_b32 s60, s97, 2
    s_add_u32 s97, s97, 1
    s_cmp_ge_u32 s97, 14
    s_cselect_b32 s97, 0, s97
    v_add_u32 v130, s60, v242
    v_xor_b32 v130, v130, v129
    v_lshlrev_b32 v130, 4, v130
    v_add_u32 v130, v130, v128
    ds_read_b128 v[152:155], v130 offset:0
    ds_read_b128 v[156:159], v130 offset:14336
    ds_read_b128 v[160:163], v130 offset:28672
    ds_read_b128 v[164:167], v130 offset:43008
    ds_read_b64_tr_b16 v[168:169], v132 offset:8192
    ds_read_b64_tr_b16 v[170:171], v132 offset:8704
    v_mfma_f32_16x16x32_bf16 v[80:83], v[188:191], v[136:139], v[80:83]
    v_mfma_f32_16x16x32_bf16 v[84:87], v[188:191], v[140:143], v[84:87]
    v_mfma_f32_16x16x32_bf16 v[88:91], v[188:191], v[144:147], v[88:91]
    v_mfma_f32_16x16x32_bf16 v[92:95], v[188:191], v[148:151], v[92:95]
    ds_read_b64_tr_b16 v[172:173], v132 offset:8200
    ds_read_b64_tr_b16 v[174:175], v132 offset:8712
    v_mfma_f32_16x16x32_bf16 v[96:99], v[192:195], v[136:139], v[96:99]
    v_mfma_f32_16x16x32_bf16 v[100:103], v[192:195], v[140:143], v[100:103]
    v_mfma_f32_16x16x32_bf16 v[104:107], v[192:195], v[144:147], v[104:107]
    v_mfma_f32_16x16x32_bf16 v[108:111], v[192:195], v[148:151], v[108:111]
    ds_read_b64_tr_b16 v[176:177], v133 offset:8192
    ds_read_b64_tr_b16 v[178:179], v133 offset:8704
    v_mfma_f32_16x16x32_bf16 v[112:115], v[196:199], v[136:139], v[112:115]
    v_mfma_f32_16x16x32_bf16 v[116:119], v[196:199], v[140:143], v[116:119]
    v_mfma_f32_16x16x32_bf16 v[120:123], v[196:199], v[144:147], v[120:123]
    v_mfma_f32_16x16x32_bf16 v[124:127], v[196:199], v[148:151], v[124:127]
    ds_read_b64_tr_b16 v[180:181], v133 offset:8200
    ds_read_b64_tr_b16 v[182:183], v133 offset:8712
    s_waitcnt lgkmcnt(6)
    v_mfma_f32_16x16x32_bf16 v[0:3], v[168:171], v[152:155], v[0:3]
    v_mfma_f32_16x16x32_bf16 v[4:7], v[168:171], v[156:159], v[4:7]
    v_mfma_f32_16x16x32_bf16 v[8:11], v[168:171], v[160:163], v[8:11]
    v_mfma_f32_16x16x32_bf16 v[12:15], v[168:171], v[164:167], v[12:15]
    s_waitcnt lgkmcnt(0)
    s_barrier
    ds_read_b64_tr_b16 v[184:185], v132 offset:12288
    ds_read_b64_tr_b16 v[186:187], v132 offset:12800
    v_mfma_f32_16x16x32_bf16 v[16:19], v[172:175], v[152:155], v[16:19]
    v_mfma_f32_16x16x32_bf16 v[20:23], v[172:175], v[156:159], v[20:23]
    v_mfma_f32_16x16x32_bf16 v[24:27], v[172:175], v[160:163], v[24:27]
    v_mfma_f32_16x16x32_bf16 v[28:31], v[172:175], v[164:167], v[28:31]
    ds_read_b64_tr_b16 v[188:189], v132 offset:12296
    ds_read_b64_tr_b16 v[190:191], v132 offset:12808
    v_mfma_f32_16x16x32_bf16 v[32:35], v[176:179], v[152:155], v[32:35]
    v_mfma_f32_16x16x32_bf16 v[36:39], v[176:179], v[156:159], v[36:39]
    v_mfma_f32_16x16x32_bf16 v[40:43], v[176:179], v[160:163], v[40:43]
    v_mfma_f32_16x16x32_bf16 v[44:47], v[176:179], v[164:167], v[44:47]
    ds_read_b64_tr_b16 v[192:193], v133 offset:12288
    ds_read_b64_tr_b16 v[194:195], v133 offset:12800
    v_mfma_f32_16x16x32_bf16 v[48:51], v[180:183], v[152:155], v[48:51]
    v_mfma_f32_16x16x32_bf16 v[52:55], v[180:183], v[156:159], v[52:55]
    v_mfma_f32_16x16x32_bf16 v[56:59], v[180:183], v[160:163], v[56:59]
    v_mfma_f32_16x16x32_bf16 v[60:63], v[180:183], v[164:167], v[60:63]
    ds_read_b64_tr_b16 v[196:197], v133 offset:12296
    ds_read_b64_tr_b16 v[198:199], v133 offset:12808
    s_waitcnt lgkmcnt(6)
    v_mfma_f32_16x16x32_bf16 v[64:67], v[184:187], v[152:155], v[64:67]
    v_mfma_f32_16x16x32_bf16 v[68:71], v[184:187], v[156:159], v[68:71]
    v_mfma_f32_16x16x32_bf16 v[72:75], v[184:187], v[160:163], v[72:75]
    v_mfma_f32_16x16x32_bf16 v[76:79], v[184:187], v[164:167], v[76:79]
    s_waitcnt lgkmcnt(4)
    v_mfma_f32_16x16x32_bf16 v[80:83], v[188:191], v[152:155], v[80:83]
    v_mfma_f32_16x16x32_bf16 v[84:87], v[188:191], v[156:159], v[84:87]
    v_mfma_f32_16x16x32_bf16 v[88:91], v[188:191], v[160:163], v[88:91]
    v_mfma_f32_16x16x32_bf16 v[92:95], v[188:191], v[164:167], v[92:95]
    s_waitcnt lgkmcnt(2)
    v_mfma_f32_16x16x32_bf16 v[96:99], v[192:195], v[152:155], v[96:99]
    v_mfma_f32_16x16x32_bf16 v[100:103], v[192:195], v[156:159], v[100:103]
    v_mfma_f32_16x16x32_bf16 v[104:107], v[192:195], v[160:163], v[104:107]
    v_mfma_f32_16x16x32_bf16 v[108:111], v[192:195], v[164:167], v[108:111]
    s_waitcnt lgkmcnt(0)
    v_mfma_f32_16x16x32_bf16 v[112:115], v[196:199], v[152:155], v[112:115]
    v_mfma_f32_16x16x32_bf16 v[116:119], v[196:199], v[156:159], v[116:119]
    v_mfma_f32_16x16x32_bf16 v[120:123], v[196:199], v[160:163], v[120:123]
    v_mfma_f32_16x16x32_bf16 v[124:127], v[196:199], v[164:167], v[124:127]
    v_lshlrev_b32 v246, 4, v254
    v_add_u32 v247, s53, v246
    s_mul_i32 s60, s58, 32768
    s_lshl_b32 s61, s59, 13
    s_add_u32 s60, s60, s61
    s_add_u32 s60, s60, 65536
    v_add_u32 v255, s60, v246
    s_nop 15
    v_cvt_pk_bf16_f32 v128, v0, v1
    v_cvt_pk_bf16_f32 v129, v2, v3
    v_cvt_pk_bf16_f32 v130, v16, v17
    v_cvt_pk_bf16_f32 v131, v18, v19
    ds_write_b128 v247, v[128:131] offset:0
    v_cvt_pk_bf16_f32 v132, v32, v33
    v_cvt_pk_bf16_f32 v133, v34, v35
    v_cvt_pk_bf16_f32 v134, v48, v49
    v_cvt_pk_bf16_f32 v135, v50, v51
    ds_write_b128 v247, v[132:135] offset:1024
    v_cvt_pk_bf16_f32 v136, v64, v65
    v_cvt_pk_bf16_f32 v137, v66, v67
    v_cvt_pk_bf16_f32 v138, v80, v81
    v_cvt_pk_bf16_f32 v139, v82, v83
    ds_write_b128 v247, v[136:139] offset:2048
    v_cvt_pk_bf16_f32 v140, v96, v97
    v_cvt_pk_bf16_f32 v141, v98, v99
    v_cvt_pk_bf16_f32 v142, v112, v113
    v_cvt_pk_bf16_f32 v143, v114, v115
    ds_write_b128 v247, v[140:143] offset:3072
    v_cvt_pk_bf16_f32 v144, v4, v5
    v_cvt_pk_bf16_f32 v145, v6, v7
    v_cvt_pk_bf16_f32 v146, v20, v21
    v_cvt_pk_bf16_f32 v147, v22, v23
    ds_write_b128 v247, v[144:147] offset:4096
    v_cvt_pk_bf16_f32 v148, v36, v37
    v_cvt_pk_bf16_f32 v149, v38, v39
    v_cvt_pk_bf16_f32 v150, v52, v53
    v_cvt_pk_bf16_f32 v151, v54, v55
    ds_write_b128 v247, v[148:151] offset:5120
    v_cvt_pk_bf16_f32 v152, v68, v69
    v_cvt_pk_bf16_f32 v153, v70, v71
    v_cvt_pk_bf16_f32 v154, v84, v85
    v_cvt_pk_bf16_f32 v155, v86, v87
    ds_write_b128 v247, v[152:155] offset:6144
    v_cvt_pk_bf16_f32 v156, v100, v101
    v_cvt_pk_bf16_f32 v157, v102, v103
    v_cvt_pk_bf16_f32 v158, v116, v117
    v_cvt_pk_bf16_f32 v159, v118, v119
    ds_write_b128 v247, v[156:159] offset:7168
    v_cvt_pk_bf16_f32 v160, v8, v9
    v_cvt_pk_bf16_f32 v161, v10, v11
    v_cvt_pk_bf16_f32 v162, v24, v25
    v_cvt_pk_bf16_f32 v163, v26, v27
    ds_write_b128 v247, v[160:163] offset:8192
    v_cvt_pk_bf16_f32 v164, v40, v41
    v_cvt_pk_bf16_f32 v165, v42, v43
    v_cvt_pk_bf16_f32 v166, v56, v57
    v_cvt_pk_bf16_f32 v167, v58, v59
    ds_write_b128 v247, v[164:167] offset:9216
    v_cvt_pk_bf16_f32 v168, v72, v73
    v_cvt_pk_bf16_f32 v169, v74, v75
    v_cvt_pk_bf16_f32 v170, v88, v89
    v_cvt_pk_bf16_f32 v171, v90, v91
    ds_write_b128 v247, v[168:171] offset:10240
    v_cvt_pk_bf16_f32 v172, v104, v105
    v_cvt_pk_bf16_f32 v173, v106, v107
    v_cvt_pk_bf16_f32 v174, v120, v121
    v_cvt_pk_bf16_f32 v175, v122, v123
    ds_write_b128 v247, v[172:175] offset:11264
    v_cvt_pk_bf16_f32 v176, v12, v13
    v_cvt_pk_bf16_f32 v177, v14, v15
    v_cvt_pk_bf16_f32 v178, v28, v29
    v_cvt_pk_bf16_f32 v179, v30, v31
    ds_write_b128 v247, v[176:179] offset:12288
    v_cvt_pk_bf16_f32 v180, v44, v45
    v_cvt_pk_bf16_f32 v181, v46, v47
    v_cvt_pk_bf16_f32 v182, v60, v61
    v_cvt_pk_bf16_f32 v183, v62, v63
    ds_write_b128 v247, v[180:183] offset:13312
    v_cvt_pk_bf16_f32 v184, v76, v77
    v_cvt_pk_bf16_f32 v185, v78, v79
    v_cvt_pk_bf16_f32 v186, v92, v93
    v_cvt_pk_bf16_f32 v187, v94, v95
    ds_write_b128 v247, v[184:187] offset:14336
    v_cvt_pk_bf16_f32 v188, v108, v109
    v_cvt_pk_bf16_f32 v189, v110, v111
    v_cvt_pk_bf16_f32 v190, v124, v125
    v_cvt_pk_bf16_f32 v191, v126, v127
    ds_write_b128 v247, v[188:191] offset:15360
    s_waitcnt lgkmcnt(0)
    s_barrier
    ds_read_b128 v[128:131], v255 offset:0
    ds_read_b128 v[132:135], v255 offset:1024
    ds_read_b128 v[136:139], v255 offset:2048
    ds_read_b128 v[140:143], v255 offset:3072
    ds_read_b128 v[144:147], v255 offset:16384
    ds_read_b128 v[148:151], v255 offset:17408
    ds_read_b128 v[152:155], v255 offset:18432
    ds_read_b128 v[156:159], v255 offset:19456
    ds_read_b128 v[160:163], v255 offset:4096
    ds_read_b128 v[164:167], v255 offset:5120
    ds_read_b128 v[168:171], v255 offset:6144
    ds_read_b128 v[172:175], v255 offset:7168
    ds_read_b128 v[176:179], v255 offset:20480
    ds_read_b128 v[180:183], v255 offset:21504
    ds_read_b128 v[184:187], v255 offset:22528
    ds_read_b128 v[188:191], v255 offset:23552
    v_mov_b32 v0, 0
    v_mov_b32 v1, 0
    v_mov_b32 v2, 0
    v_mov_b32 v3, 0
    v_mov_b32 v4, 0
    v_mov_b32 v5, 0
    v_mov_b32 v6, 0
    v_mov_b32 v7, 0
    v_mov_b32 v8, 0
    v_mov_b32 v9, 0
    v_mov_b32 v10, 0
    v_mov_b32 v11, 0
    v_mov_b32 v12, 0
    v_mov_b32 v13, 0
    v_mov_b32 v14, 0
    v_mov_b32 v15, 0
    v_mov_b32 v16, 0
    v_mov_b32 v17, 0
    v_mov_b32 v18, 0
    v_mov_b32 v19, 0
    v_mov_b32 v20, 0
    v_mov_b32 v21, 0
    v_mov_b32 v22, 0
    v_mov_b32 v23, 0
    v_mov_b32 v24, 0
    v_mov_b32 v25, 0
    v_mov_b32 v26, 0
    v_mov_b32 v27, 0
    v_mov_b32 v28, 0
    v_mov_b32 v29, 0
    v_mov_b32 v30, 0
    v_mov_b32 v31, 0
    v_mov_b32 v32, 0
    v_mov_b32 v33, 0
    v_mov_b32 v34, 0
    v_mov_b32 v35, 0
    v_mov_b32 v36, 0
    v_mov_b32 v37, 0
    v_mov_b32 v38, 0
    v_mov_b32 v39, 0
    v_mov_b32 v40, 0
    v_mov_b32 v41, 0
    v_mov_b32 v42, 0
    v_mov_b32 v43, 0
    v_mov_b32 v44, 0
    v_mov_b32 v45, 0
    v_mov_b32 v46, 0
    v_mov_b32 v47, 0
    v_mov_b32 v48, 0
    v_mov_b32 v49, 0
    v_mov_b32 v50, 0
    v_mov_b32 v51, 0
    v_mov_b32 v52, 0
    v_mov_b32 v53, 0
    v_mov_b32 v54, 0
    v_mov_b32 v55, 0
    v_mov_b32 v56, 0
    v_mov_b32 v57, 0
    v_mov_b32 v58, 0
    v_mov_b32 v59, 0
    v_mov_b32 v60, 0
    v_mov_b32 v61, 0
    v_mov_b32 v62, 0
    v_mov_b32 v63, 0
    v_mov_b32 v64, 0
    v_mov_b32 v65, 0
    v_mov_b32 v66, 0
    v_mov_b32 v67, 0
    v_mov_b32 v68, 0
    v_mov_b32 v69, 0
    v_mov_b32 v70, 0
    v_mov_b32 v71, 0
    v_mov_b32 v72, 0
    v_mov_b32 v73, 0
    v_mov_b32 v74, 0
    v_mov_b32 v75, 0
    v_mov_b32 v76, 0
    v_mov_b32 v77, 0
    v_mov_b32 v78, 0
    v_mov_b32 v79, 0
    v_mov_b32 v80, 0
    v_mov_b32 v81, 0
    v_mov_b32 v82, 0
    v_mov_b32 v83, 0
    v_mov_b32 v84, 0
    v_mov_b32 v85, 0
    v_mov_b32 v86, 0
    v_mov_b32 v87, 0
    v_mov_b32 v88, 0
    v_mov_b32 v89, 0
    v_mov_b32 v90, 0
    v_mov_b32 v91, 0
    v_mov_b32 v92, 0
    v_mov_b32 v93, 0
    v_mov_b32 v94, 0
    v_mov_b32 v95, 0
    v_mov_b32 v96, 0
    v_mov_b32 v97, 0
    v_mov_b32 v98, 0
    v_mov_b32 v99, 0
    v_mov_b32 v100, 0
    v_mov_b32 v101, 0
    v_mov_b32 v102, 0
    v_mov_b32 v103, 0
    v_mov_b32 v104, 0
    v_mov_b32 v105, 0
    v_mov_b32 v106, 0
    v_mov_b32 v107, 0
    v_mov_b32 v108, 0
    v_mov_b32 v109, 0
    v_mov_b32 v110, 0
    v_mov_b32 v111, 0
    v_mov_b32 v112, 0
    v_mov_b32 v113, 0
    v_mov_b32 v114, 0
    v_mov_b32 v115, 0
    v_mov_b32 v116, 0
    v_mov_b32 v117, 0
    v_mov_b32 v118, 0
    v_mov_b32 v119, 0
    v_mov_b32 v120, 0
    v_mov_b32 v121, 0
    v_mov_b32 v122, 0
    v_mov_b32 v123, 0
    v_mov_b32 v124, 0
    v_mov_b32 v125, 0
    v_mov_b32 v126, 0
    v_mov_b32 v127, 0
    v_mov_b32 v236, 0xff800000
    v_mov_b32 v238, 0
    v_mov_b32 v237, 0xff800000
    v_mov_b32 v239, 0
    s_mov_b32 s57, 0x3db8aa3b
    s_mov_b32 s54, 0
    s_mov_b32 s74, 32768
    s_mov_b32 s75, 4294836224
    s_mov_b32 s38, 4
    s_waitcnt lgkmcnt(0)
    s_barrier
L_loop:
    s_barrier
    ds_read_b128 v[216:219], v232 offset:0
    ds_read_b128 v[220:223], v232 offset:8192
    v_xor_b32 v234, 64, v232
    ds_read_b128 v[224:227], v234 offset:0
    ds_read_b128 v[228:231], v234 offset:8192
    s_waitcnt lgkmcnt(3)
    v_mfma_f32_16x16x32_bf16 v[192:195], v[216:219], v[128:131], 0
    v_mfma_f32_16x16x32_bf16 v[200:203], v[216:219], v[160:163], 0
    v_xor_b32 v234, 128, v232
    ds_read_b128 v[216:219], v234 offset:0
    s_waitcnt lgkmcnt(3)
    v_mfma_f32_16x16x32_bf16 v[196:199], v[220:223], v[128:131], 0
    v_mfma_f32_16x16x32_bf16 v[204:207], v[220:223], v[160:163], 0
    ds_read_b128 v[220:223], v234 offset:8192
    s_waitcnt lgkmcnt(3)
    v_mfma_f32_16x16x32_bf16 v[192:195], v[224:227], v[132:135], v[192:195]
    v_mfma_f32_16x16x32_bf16 v[200:203], v[224:227], v[164:167], v[200:203]
    v_xor_b32 v234, 192, v232
    ds_read_b128 v[224:227], v234 offset:0
    s_waitcnt lgkmcnt(3)
    v_mfma_f32_16x16x32_bf16 v[196:199], v[228:231], v[132:135], v[196:199]
    v_mfma_f32_16x16x32_bf16 v[204:207], v[228:231], v[164:167], v[204:207]
    ds_read_b128 v[228:231], v234 offset:8192
    s_waitcnt lgkmcnt(3)
    v_mfma_f32_16x16x32_bf16 v[192:195], v[216:219], v[136:139], v[192:195]
    v_mfma_f32_16x16x32_bf16 v[200:203], v[216:219], v[168:171], v[200:203]
    ds_read_b128 v[216:219], v232 offset:256
    s_waitcnt lgkmcnt(3)
    v_mfma_f32_16x16x32_bf16 v[196:199], v[220:223], v[136:139], v[196:199]
    v_mfma_f32_16x16x32_bf16 v[204:207], v[220:223], v[168:171], v[204:207]
    ds_read_b128 v[220:223], v232 offset:8448
    s_waitcnt lgkmcnt(3)
    v_mfma_f32_16x16x32_bf16 v[192:195], v[224:227], v[140:143], v[192:195]
    v_mfma_f32_16x16x32_bf16 v[200:203], v[224:227], v[172:175], v[200:203]
    v_xor_b32 v234, 64, v232
    ds_read_b128 v[224:227], v234 offset:256
    s_waitcnt lgkmcnt(3)
    v_mfma_f32_16x16x32_bf16 v[196:199], v[228:231], v[140:143], v[196:199]
    v_mfma_f32_16x16x32_bf16 v[204:207], v[228:231], v[172:175], v[204:207]
    ds_read_b128 v[228:231], v234 offset:8448
    s_waitcnt lgkmcnt(3)
    v_mfma_f32_16x16x32_bf16 v[192:195], v[216:219], v[144:147], v[192:195]
    v_mfma_f32_16x16x32_bf16 v[200:203], v[216:219], v[176:179], v[200:203]
    v_xor_b32 v234, 128, v232
    ds_read_b128 v[216:219], v234 offset:256
    s_waitcnt lgkmcnt(3)
    v_mfma_f32_16x16x32_bf16 v[196:199], v[220:223], v[144:147], v[196:199]
    v_mfma_f32_16x16x32_bf16 v[204:207], v[220:223], v[176:179], v[204:207]
    ds_read_b128 v[220:223], v234 offset:8448
    s_waitcnt lgkmcnt(3)
    v_mfma_f32_16x16x32_bf16 v[192:195], v[224:227], v[148:151], v[192:195]
    v_mfma_f32_16x16x32_bf16 v[200:203], v[224:227], v[180:183], v[200:203]
    v_xor_b32 v234, 192, v232
    ds_read_b128 v[224:227], v234 offset:256
    s_waitcnt lgkmcnt(3)
    v_mfma_f32_16x16x32_bf16 v[196:199], v[228:231], v[148:151], v[196:199]
    v_mfma_f32_16x16x32_bf16 v[204:207], v[228:231], v[180:183], v[204:207]
    ds_read_b128 v[228:231], v234 offset:8448
    s_waitcnt lgkmcnt(3)
    v_mfma_f32_16x16x32_bf16 v[192:195], v[216:219], v[152:155], v[192:195]
    v_mfma_f32_16x16x32_bf16 v[200:203], v[216:219], v[184:187], v[200:203]
    ds_read_b64_tr_b16 v[216:217], v233 offset:0
    ds_read_b64_tr_b16 v[218:219], v233 offset:8192
    s_waitcnt lgkmcnt(4)
    v_mfma_f32_16x16x32_bf16 v[196:199], v[220:223], v[152:155], v[196:199]
    v_mfma_f32_16x16x32_bf16 v[204:207], v[220:223], v[184:187], v[204:207]
    v_xor_b32 v235, 32, v233
    ds_read_b64_tr_b16 v[220:221], v235 offset:0
    ds_read_b64_tr_b16 v[222:223], v235 offset:8192
    s_waitcnt lgkmcnt(5)
    v_mfma_f32_16x16x32_bf16 v[192:195], v[224:227], v[156:159], v[192:195]
    v_mfma_f32_16x16x32_bf16 v[200:203], v[224:227], v[188:191], v[200:203]
    v_xor_b32 v235, 64, v233
    ds_read_b64_tr_b16 v[224:225], v235 offset:0
    ds_read_b64_tr_b16 v[226:227], v235 offset:8192
    s_waitcnt lgkmcnt(6)
    v_mfma_f32_16x16x32_bf16 v[196:199], v[228:231], v[156:159], v[196:199]
    v_mfma_f32_16x16x32_bf16 v[204:207], v[228:231], v[188:191], v[204:207]
    v_xor_b32 v235, 96, v233
    ds_read_b64_tr_b16 v[228:229], v235 offset:0
    ds_read_b64_tr_b16 v[230:231], v235 offset:8192
    s_add_u32 s38, s38, 1
    s_cmp_eq_u32 s38, 5
    s_cselect_b32 s39, s75, s74
    s_cselect_b32 s38, 0, s38
    v_add_u32 v232, s39, v232
    s_nop 4
    v_max3_f32 v242, v192, v193, v194
    v_max3_f32 v243, v195, v196, v197
    v_max3_f32 v242, v242, v198, v199
    v_max_f32 v242, v242, v243
    v_mov_b32 v243, v242
    v_max3_f32 v244, v200, v201, v202
    v_max3_f32 v245, v203, v204, v205
    v_max3_f32 v244, v244, v206, v207
    v_max_f32 v244, v244, v245
    v_mov_b32 v245, v244
    s_nop 0
    v_permlane16_swap_b32 v242, v243
    v_permlane16_swap_b32 v244, v245
    s_nop 0
    v_max_f32 v242, v242, v243
    v_mov_b32 v243, v242
    v_max_f32 v244, v244, v245
    v_mov_b32 v245, v244
    s_nop 1
    v_permlane32_swap_b32 v242, v243
    v_permlane32_swap_b32 v244, v245
    s_nop 0
    v_max_f32 v242, v242, v243
    v_mul_f32 v240, s57, v242
    v_sub_f32 v243, v240, v236
    v_max_f32 v244, v244, v245
    v_mul_f32 v241, s57, v244
    v_sub_f32 v245, v241, v237
    v_max_f32 v242, v243, v245
    v_cmp_lt_f32 vcc, 0x41000000, v242
    s_nop 1
    s_cbranch_vccnz L_rescale
L_rescale_done:
    v_fma_f32 v192, v192, s57, -v236
    v_fma_f32 v193, v193, s57, -v236
    v_fma_f32 v194, v194, s57, -v236
    v_fma_f32 v195, v195, s57, -v236
    v_fma_f32 v196, v196, s57, -v236
    v_fma_f32 v197, v197, s57, -v236
    v_fma_f32 v198, v198, s57, -v236
    v_fma_f32 v199, v199, s57, -v236
    v_fma_f32 v200, v200, s57, -v237
    v_fma_f32 v201, v201, s57, -v237
    v_fma_f32 v202, v202, s57, -v237
    v_fma_f32 v203, v203, s57, -v237
    v_fma_f32 v204, v204, s57, -v237
    v_fma_f32 v205, v205, s57, -v237
    v_fma_f32 v206, v206, s57, -v237
    v_fma_f32 v207, v207, s57, -v237
    v_exp_f32 v192, v192
    v_exp_f32 v193, v193
    v_exp_f32 v194, v194
    v_exp_f32 v195, v195
    v_exp_f32 v196, v196
    v_exp_f32 v197, v197
    v_exp_f32 v198, v198
    v_exp_f32 v199, v199
    v_exp_f32 v200, v200
    v_exp_f32 v201, v201
    v_exp_f32 v202, v202
    v_exp_f32 v203, v203
    v_exp_f32 v204, v204
    v_exp_f32 v205, v205
    v_exp_f32 v206, v206
    v_exp_f32 v207, v207
    s_nop 0
    v_cvt_pk_bf16_f32 v208, v192, v193
    v_cvt_pk_bf16_f32 v209, v194, v195
    v_cvt_pk_bf16_f32 v210, v196, v197
    v_cvt_pk_bf16_f32 v211, v198, v199
    v_cvt_pk_bf16_f32 v212, v200, v201
    v_cvt_pk_bf16_f32 v213, v202, v203
    v_cvt_pk_bf16_f32 v214, v204, v205
    v_cvt_pk_bf16_f32 v215, v206, v207
    s_nop 1
    s_waitcnt lgkmcnt(6)
    v_mfma_f32_16x16x32_bf16 v[0:3], v[216:219], v[208:211], v[0:3]
    v_mfma_f32_16x16x32_bf16 v[4:7], v[216:219], v[212:215], v[4:7]
    v_xor_b32 v235, 128, v233
    ds_read_b64_tr_b16 v[216:217], v235 offset:0
    ds_read_b64_tr_b16 v[218:219], v235 offset:8192
    v_add_f32 v242, v192, v193
    s_waitcnt lgkmcnt(6)
    v_mfma_f32_16x16x32_bf16 v[8:11], v[220:223], v[208:211], v[8:11]
    v_mfma_f32_16x16x32_bf16 v[12:15], v[220:223], v[212:215], v[12:15]
    v_xor_b32 v235, 160, v233
    ds_read_b64_tr_b16 v[220:221], v235 offset:0
    ds_read_b64_tr_b16 v[222:223], v235 offset:8192
    v_add_f32 v243, v194, v195
    s_waitcnt lgkmcnt(6)
    v_mfma_f32_16x16x32_bf16 v[16:19], v[224:227], v[208:211], v[16:19]
    v_mfma_f32_16x16x32_bf16 v[20:23], v[224:227], v[212:215], v[20:23]
    v_xor_b32 v235, 192, v233
    ds_read_b64_tr_b16 v[224:225], v235 offset:0
    ds_read_b64_tr_b16 v[226:227], v235 offset:8192
    v_add_f32 v242, v242, v196
    s_waitcnt lgkmcnt(6)
    v_mfma_f32_16x16x32_bf16 v[24:27], v[228:231], v[208:211], v[24:27]
    v_mfma_f32_16x16x32_bf16 v[28:31], v[228:231], v[212:215], v[28:31]
    v_xor_b32 v235, 224, v233
    ds_read_b64_tr_b16 v[228:229], v235 offset:0
    ds_read_b64_tr_b16 v[230:231], v235 offset:8192
    v_add_f32 v243, v243, v197
    s_waitcnt lgkmcnt(6)
    v_mfma_f32_16x16x32_bf16 v[32:35], v[216:219], v[208:211], v[32:35]
    v_mfma_f32_16x16x32_bf16 v[36:39], v[216:219], v[212:215], v[36:39]
    ds_read_b64_tr_b16 v[216:217], v233 offset:256
    ds_read_b64_tr_b16 v[218:219], v233 offset:8448
    v_add_f32 v242, v242, v198
    s_waitcnt lgkmcnt(6)
    v_mfma_f32_16x16x32_bf16 v[40:43], v[220:223], v[208:211], v[40:43]
    v_mfma_f32_16x16x32_bf16 v[44:47], v[220:223], v[212:215], v[44:47]
    v_xor_b32 v235, 32, v233
    ds_read_b64_tr_b16 v[220:221], v235 offset:256
    ds_read_b64_tr_b16 v[222:223], v235 offset:8448
    v_add_f32 v243, v243, v199
    s_waitcnt lgkmcnt(6)
    v_mfma_f32_16x16x32_bf16 v[48:51], v[224:227], v[208:211], v[48:51]
    v_mfma_f32_16x16x32_bf16 v[52:55], v[224:227], v[212:215], v[52:55]
    v_xor_b32 v235, 64, v233
    ds_read_b64_tr_b16 v[224:225], v235 offset:256
    ds_read_b64_tr_b16 v[226:227], v235 offset:8448
    v_add_f32 v242, v242, v243
    s_waitcnt lgkmcnt(6)
    v_mfma_f32_16x16x32_bf16 v[56:59], v[228:231], v[208:211], v[56:59]
    v_mfma_f32_16x16x32_bf16 v[60:63], v[228:231], v[212:215], v[60:63]
    v_xor_b32 v235, 96, v233
    ds_read_b64_tr_b16 v[228:229], v235 offset:256
    ds_read_b64_tr_b16 v[230:231], v235 offset:8448
    v_add_f32 v238, v238, v242
    s_waitcnt lgkmcnt(6)
    v_mfma_f32_16x16x32_bf16 v[64:67], v[216:219], v[208:211], v[64:67]
    v_mfma_f32_16x16x32_bf16 v[68:71], v[216:219], v[212:215], v[68:71]
    v_xor_b32 v235, 128, v233
    ds_read_b64_tr_b16 v[216:217], v235 offset:256
    ds_read_b64_tr_b16 v[218:219], v235 offset:8448
    v_add_f32 v244, v200, v201
    s_waitcnt lgkmcnt(6)
    v_mfma_f32_16x16x32_bf16 v[72:75], v[220:223], v[208:211], v[72:75]
    v_mfma_f32_16x16x32_bf16 v[76:79], v[220:223], v[212:215], v[76:79]
    v_xor_b32 v235, 160, v233
    ds_read_b64_tr_b16 v[220:221], v235 offset:256
    ds_read_b64_tr_b16 v[222:223], v235 offset:8448
    v_add_f32 v245, v202, v203
    s_waitcnt lgkmcnt(6)
    v_mfma_f32_16x16x32_bf16 v[80:83], v[224:227], v[208:211], v[80:83]
    v_mfma_f32_16x16x32_bf16 v[84:87], v[224:227], v[212:215], v[84:87]
    v_xor_b32 v235, 192, v233
    ds_read_b64_tr_b16 v[224:225], v235 offset:256
    ds_read_b64_tr_b16 v[226:227], v235 offset:8448
    v_add_f32 v244, v244, v204
    s_waitcnt lgkmcnt(6)
    v_mfma_f32_16x16x32_bf16 v[88:91], v[228:231], v[208:211], v[88:91]
    v_mfma_f32_16x16x32_bf16 v[92:95], v[228:231], v[212:215], v[92:95]
    v_xor_b32 v235, 224, v233
    ds_read_b64_tr_b16 v[228:229], v235 offset:256
    ds_read_b64_tr_b16 v[230:231], v235 offset:8448
    v_add_f32 v245, v245, v205
    s_waitcnt lgkmcnt(6)
    v_mfma_f32_16x16x32_bf16 v[96:99], v[216:219], v[208:211], v[96:99]
    v_mfma_f32_16x16x32_bf16 v[100:103], v[216:219], v[212:215], v[100:103]
    v_add_f32 v244, v244, v206
    s_waitcnt lgkmcnt(4)
    v_mfma_f32_16x16x32_bf16 v[104:107], v[220:223], v[208:211], v[104:107]
    v_mfma_f32_16x16x32_bf16 v[108:111], v[220:223], v[212:215], v[108:111]
    v_add_f32 v245, v245, v207
    s_waitcnt lgkmcnt(2)
    v_mfma_f32_16x16x32_bf16 v[112:115], v[224:227], v[208:211], v[112:115]
    v_mfma_f32_16x16x32_bf16 v[116:119], v[224:227], v[212:215], v[116:119]
    v_add_f32 v244, v244, v245
    s_waitcnt lgkmcnt(0)
    v_mfma_f32_16x16x32_bf16 v[120:123], v[228:231], v[208:211], v[120:123]
    v_mfma_f32_16x16x32_bf16 v[124:127], v[228:231], v[212:215], v[124:127]
    v_add_f32 v239, v239, v244
    v_add_u32 v233, s39, v233
    s_add_u32 s54, s54, 1
    s_cmp_lt_u32 s54, 32
    s_cbranch_scc1 L_loop
    v_mov_b32 v242, v238
    v_mov_b32 v243, v239
    s_nop 1
    v_permlane16_swap_b32 v238, v242
    v_permlane16_swap_b32 v239, v243
    s_nop 0
    v_add_f32 v238, v238, v242
    v_mov_b32 v242, v238
    v_add_f32 v239, v239, v243
    v_mov_b32 v243, v239
    s_nop 1
    v_permlane32_swap_b32 v238, v242
    v_permlane32_swap_b32 v239, v243
    s_nop 0
    v_add_f32 v238, v238, v242
    v_rcp_f32 v240, v238
    v_add_f32 v239, v239, v243
    v_rcp_f32 v241, v239
    s_lshl_b32 s61, s59, 14
    s_add_u32 s61, s61, 98304
    s_add_u32 s60, s61, 32768
    s_cmp_eq_u32 s58, 0
    s_cselect_b32 s62, s61, s60
    v_lshlrev_b32 v246, 4, v254
    v_add_u32 v232, s61, v246
    v_add_u32 v234, s62, v246
    s_nop 7
    v_mul_f32 v0, v0, v240
    v_mul_f32 v1, v1, v240
    v_mul_f32 v2, v2, v240
    v_mul_f32 v3, v3, v240
    v_cvt_pk_bf16_f32 v128, v0, v1
    v_cvt_pk_bf16_f32 v129, v2, v3
    v_mul_f32 v8, v8, v240
    v_mul_f32 v9, v9, v240
    v_mul_f32 v10, v10, v240
    v_mul_f32 v11, v11, v240
    v_cvt_pk_bf16_f32 v130, v8, v9
    v_cvt_pk_bf16_f32 v131, v10, v11
    ds_write_b128 v234, v[128:131] offset:0
    v_mul_f32 v4, v4, v241
    v_mul_f32 v5, v5, v241
    v_mul_f32 v6, v6, v241
    v_mul_f32 v7, v7, v241
    v_cvt_pk_bf16_f32 v132, v4, v5
    v_cvt_pk_bf16_f32 v133, v6, v7
    v_mul_f32 v12, v12, v241
    v_mul_f32 v13, v13, v241
    v_mul_f32 v14, v14, v241
    v_mul_f32 v15, v15, v241
    v_cvt_pk_bf16_f32 v134, v12, v13
    v_cvt_pk_bf16_f32 v135, v14, v15
    ds_write_b128 v234, v[132:135] offset:1024
    v_mul_f32 v16, v16, v240
    v_mul_f32 v17, v17, v240
    v_mul_f32 v18, v18, v240
    v_mul_f32 v19, v19, v240
    v_cvt_pk_bf16_f32 v136, v16, v17
    v_cvt_pk_bf16_f32 v137, v18, v19
    v_mul_f32 v24, v24, v240
    v_mul_f32 v25, v25, v240
    v_mul_f32 v26, v26, v240
    v_mul_f32 v27, v27, v240
    v_cvt_pk_bf16_f32 v138, v24, v25
    v_cvt_pk_bf16_f32 v139, v26, v27
    ds_write_b128 v234, v[136:139] offset:2048
    v_mul_f32 v20, v20, v241
    v_mul_f32 v21, v21, v241
    v_mul_f32 v22, v22, v241
    v_mul_f32 v23, v23, v241
    v_cvt_pk_bf16_f32 v140, v20, v21
    v_cvt_pk_bf16_f32 v141, v22, v23
    v_mul_f32 v28, v28, v241
    v_mul_f32 v29, v29, v241
    v_mul_f32 v30, v30, v241
    v_mul_f32 v31, v31, v241
    v_cvt_pk_bf16_f32 v142, v28, v29
    v_cvt_pk_bf16_f32 v143, v30, v31
    ds_write_b128 v234, v[140:143] offset:3072
    v_mul_f32 v32, v32, v240
    v_mul_f32 v33, v33, v240
    v_mul_f32 v34, v34, v240
    v_mul_f32 v35, v35, v240
    v_cvt_pk_bf16_f32 v144, v32, v33
    v_cvt_pk_bf16_f32 v145, v34, v35
    v_mul_f32 v40, v40, v240
    v_mul_f32 v41, v41, v240
    v_mul_f32 v42, v42, v240
    v_mul_f32 v43, v43, v240
    v_cvt_pk_bf16_f32 v146, v40, v41
    v_cvt_pk_bf16_f32 v147, v42, v43
    ds_write_b128 v234, v[144:147] offset:4096
    v_mul_f32 v36, v36, v241
    v_mul_f32 v37, v37, v241
    v_mul_f32 v38, v38, v241
    v_mul_f32 v39, v39, v241
    v_cvt_pk_bf16_f32 v148, v36, v37
    v_cvt_pk_bf16_f32 v149, v38, v39
    v_mul_f32 v44, v44, v241
    v_mul_f32 v45, v45, v241
    v_mul_f32 v46, v46, v241
    v_mul_f32 v47, v47, v241
    v_cvt_pk_bf16_f32 v150, v44, v45
    v_cvt_pk_bf16_f32 v151, v46, v47
    ds_write_b128 v234, v[148:151] offset:5120
    v_mul_f32 v48, v48, v240
    v_mul_f32 v49, v49, v240
    v_mul_f32 v50, v50, v240
    v_mul_f32 v51, v51, v240
    v_cvt_pk_bf16_f32 v152, v48, v49
    v_cvt_pk_bf16_f32 v153, v50, v51
    v_mul_f32 v56, v56, v240
    v_mul_f32 v57, v57, v240
    v_mul_f32 v58, v58, v240
    v_mul_f32 v59, v59, v240
    v_cvt_pk_bf16_f32 v154, v56, v57
    v_cvt_pk_bf16_f32 v155, v58, v59
    ds_write_b128 v234, v[152:155] offset:6144
    v_mul_f32 v52, v52, v241
    v_mul_f32 v53, v53, v241
    v_mul_f32 v54, v54, v241
    v_mul_f32 v55, v55, v241
    v_cvt_pk_bf16_f32 v156, v52, v53
    v_cvt_pk_bf16_f32 v157, v54, v55
    v_mul_f32 v60, v60, v241
    v_mul_f32 v61, v61, v241
    v_mul_f32 v62, v62, v241
    v_mul_f32 v63, v63, v241
    v_cvt_pk_bf16_f32 v158, v60, v61
    v_cvt_pk_bf16_f32 v159, v62, v63
    ds_write_b128 v234, v[156:159] offset:7168
    v_mul_f32 v64, v64, v240
    v_mul_f32 v65, v65, v240
    v_mul_f32 v66, v66, v240
    v_mul_f32 v67, v67, v240
    v_cvt_pk_bf16_f32 v160, v64, v65
    v_cvt_pk_bf16_f32 v161, v66, v67
    v_mul_f32 v72, v72, v240
    v_mul_f32 v73, v73, v240
    v_mul_f32 v74, v74, v240
    v_mul_f32 v75, v75, v240
    v_cvt_pk_bf16_f32 v162, v72, v73
    v_cvt_pk_bf16_f32 v163, v74, v75
    ds_write_b128 v234, v[160:163] offset:8192
    v_mul_f32 v68, v68, v241
    v_mul_f32 v69, v69, v241
    v_mul_f32 v70, v70, v241
    v_mul_f32 v71, v71, v241
    v_cvt_pk_bf16_f32 v164, v68, v69
    v_cvt_pk_bf16_f32 v165, v70, v71
    v_mul_f32 v76, v76, v241
    v_mul_f32 v77, v77, v241
    v_mul_f32 v78, v78, v241
    v_mul_f32 v79, v79, v241
    v_cvt_pk_bf16_f32 v166, v76, v77
    v_cvt_pk_bf16_f32 v167, v78, v79
    ds_write_b128 v234, v[164:167] offset:9216
    v_mul_f32 v80, v80, v240
    v_mul_f32 v81, v81, v240
    v_mul_f32 v82, v82, v240
    v_mul_f32 v83, v83, v240
    v_cvt_pk_bf16_f32 v168, v80, v81
    v_cvt_pk_bf16_f32 v169, v82, v83
    v_mul_f32 v88, v88, v240
    v_mul_f32 v89, v89, v240
    v_mul_f32 v90, v90, v240
    v_mul_f32 v91, v91, v240
    v_cvt_pk_bf16_f32 v170, v88, v89
    v_cvt_pk_bf16_f32 v171, v90, v91
    ds_write_b128 v234, v[168:171] offset:10240
    v_mul_f32 v84, v84, v241
    v_mul_f32 v85, v85, v241
    v_mul_f32 v86, v86, v241
    v_mul_f32 v87, v87, v241
    v_cvt_pk_bf16_f32 v172, v84, v85
    v_cvt_pk_bf16_f32 v173, v86, v87
    v_mul_f32 v92, v92, v241
    v_mul_f32 v93, v93, v241
    v_mul_f32 v94, v94, v241
    v_mul_f32 v95, v95, v241
    v_cvt_pk_bf16_f32 v174, v92, v93
    v_cvt_pk_bf16_f32 v175, v94, v95
    ds_write_b128 v234, v[172:175] offset:11264
    v_mul_f32 v96, v96, v240
    v_mul_f32 v97, v97, v240
    v_mul_f32 v98, v98, v240
    v_mul_f32 v99, v99, v240
    v_cvt_pk_bf16_f32 v176, v96, v97
    v_cvt_pk_bf16_f32 v177, v98, v99
    v_mul_f32 v104, v104, v240
    v_mul_f32 v105, v105, v240
    v_mul_f32 v106, v106, v240
    v_mul_f32 v107, v107, v240
    v_cvt_pk_bf16_f32 v178, v104, v105
    v_cvt_pk_bf16_f32 v179, v106, v107
    ds_write_b128 v234, v[176:179] offset:12288
    v_mul_f32 v100, v100, v241
    v_mul_f32 v101, v101, v241
    v_mul_f32 v102, v102, v241
    v_mul_f32 v103, v103, v241
    v_cvt_pk_bf16_f32 v180, v100, v101
    v_cvt_pk_bf16_f32 v181, v102, v103
    v_mul_f32 v108, v108, v241
    v_mul_f32 v109, v109, v241
    v_mul_f32 v110, v110, v241
    v_mul_f32 v111, v111, v241
    v_cvt_pk_bf16_f32 v182, v108, v109
    v_cvt_pk_bf16_f32 v183, v110, v111
    ds_write_b128 v234, v[180:183] offset:13312
    v_mul_f32 v112, v112, v240
    v_mul_f32 v113, v113, v240
    v_mul_f32 v114, v114, v240
    v_mul_f32 v115, v115, v240
    v_cvt_pk_bf16_f32 v184, v112, v113
    v_cvt_pk_bf16_f32 v185, v114, v115
    v_mul_f32 v120, v120, v240
    v_mul_f32 v121, v121, v240
    v_mul_f32 v122, v122, v240
    v_mul_f32 v123, v123, v240
    v_cvt_pk_bf16_f32 v186, v120, v121
    v_cvt_pk_bf16_f32 v187, v122, v123
    ds_write_b128 v234, v[184:187] offset:14336
    v_mul_f32 v116, v116, v241
    v_mul_f32 v117, v117, v241
    v_mul_f32 v118, v118, v241
    v_mul_f32 v119, v119, v241
    v_cvt_pk_bf16_f32 v188, v116, v117
    v_cvt_pk_bf16_f32 v189, v118, v119
    v_mul_f32 v124, v124, v241
    v_mul_f32 v125, v125, v241
    v_mul_f32 v126, v126, v241
    v_mul_f32 v127, v127, v241
    v_cvt_pk_bf16_f32 v190, v124, v125
    v_cvt_pk_bf16_f32 v191, v126, v127
    ds_write_b128 v234, v[188:191] offset:15360
    v_lshrrev_b32 v242, 4, v254
    v_and_b32 v243, 15, v254
    v_bfe_u32 v244, v254, 2, 2
    v_and_b32 v245, 3, v254
    v_lshlrev_b32 v246, 2, v242
    v_add_u32 v246, v246, v244
    v_bfe_u32 v248, v246, 1, 2
    v_mul_u32_u24 v246, 896, v246
    v_lshlrev_b32 v247, 3, v245
    v_add_u32 v246, v246, v247
    s_mul_i32 s60, s58, 448
    s_add_u32 s60, s60, 32768
    v_add_u32 v246, s60, v246
    s_lshl_b32 s61, s58, 1
    s_add_u32 s62, s61, 0
    s_and_b32 s62, s62, 3
    v_xor_b32 v247, s62, v248
    v_subrev_u32 v247, s62, v247
    v_lshlrev_b32 v247, 5, v247
    v_add_u32 v200, v246, v247
    s_add_u32 s62, s61, 1
    s_and_b32 s62, s62, 3
    v_xor_b32 v247, s62, v248
    v_subrev_u32 v247, s62, v247
    v_lshlrev_b32 v247, 5, v247
    v_add_u32 v201, v246, v247
    s_add_u32 s62, s61, 2
    s_and_b32 s62, s62, 3
    v_xor_b32 v247, s62, v248
    v_subrev_u32 v247, s62, v247
    v_lshlrev_b32 v247, 5, v247
    v_add_u32 v202, v246, v247
    s_add_u32 s62, s61, 3
    s_and_b32 s62, s62, 3
    v_xor_b32 v247, s62, v248
    v_subrev_u32 v247, s62, v247
    v_lshlrev_b32 v247, 5, v247
    v_add_u32 v203, v246, v247
    s_waitcnt lgkmcnt(0)
    s_mov_b32 s96, s36
    s_lshr_b32 s60, s96, 3
    s_lshl_b32 s60, s60, 15
    s_and_b32 s61, s96, 7
    s_lshl_b32 s61, s61, 11
    s_add_u32 s60, s60, s61
    v_add_u32 v233, s60, v232
    s_add_u32 s96, s96, 1
    s_and_b32 s96, s96, 15
    s_barrier
    ds_read_b128 v[192:195], v233 offset:0
    ds_read_b128 v[196:199], v233 offset:1024
    ds_read_b64_tr_b16 v[128:129], v200 offset:0
    ds_read_b64_tr_b16 v[130:131], v200 offset:14336
    ds_read_b64_tr_b16 v[132:133], v201 offset:32
    ds_read_b64_tr_b16 v[134:135], v201 offset:14368
    ds_read_b64_tr_b16 v[136:137], v202 offset:64
    ds_read_b64_tr_b16 v[138:139], v202 offset:14400
    ds_read_b64_tr_b16 v[140:141], v203 offset:96
    ds_read_b64_tr_b16 v[142:143], v203 offset:14432
    ds_read_b64_tr_b16 v[144:145], v200 offset:128
    ds_read_b64_tr_b16 v[146:147], v200 offset:14464
    ds_read_b64_tr_b16 v[148:149], v201 offset:160
    ds_read_b64_tr_b16 v[150:151], v201 offset:14496
    s_waitcnt lgkmcnt(10)
    v_mfma_f32_16x16x32_bf16 v[0:3], v[128:131], v[192:195], 0
    v_mfma_f32_16x16x32_bf16 v[4:7], v[128:131], v[196:199], 0
    ds_read_b64_tr_b16 v[152:153], v202 offset:192
    ds_read_b64_tr_b16 v[154:155], v202 offset:14528
    s_waitcnt lgkmcnt(10)
    v_mfma_f32_16x16x32_bf16 v[8:11], v[132:135], v[192:195], 0
    v_mfma_f32_16x16x32_bf16 v[12:15], v[132:135], v[196:199], 0
    ds_read_b64_tr_b16 v[156:157], v203 offset:224
    ds_read_b64_tr_b16 v[158:159], v203 offset:14560
    s_waitcnt lgkmcnt(10)
    v_mfma_f32_16x16x32_bf16 v[16:19], v[136:139], v[192:195], 0
    v_mfma_f32_16x16x32_bf16 v[20:23], v[136:139], v[196:199], 0
    ds_read_b64_tr_b16 v[128:129], v200 offset:256
    ds_read_b64_tr_b16 v[130:131], v200 offset:14592
    s_waitcnt lgkmcnt(10)
    v_mfma_f32_16x16x32_bf16 v[24:27], v[140:143], v[192:195], 0
    v_mfma_f32_16x16x32_bf16 v[28:31], v[140:143], v[196:199], 0
    ds_read_b64_tr_b16 v[132:133], v201 offset:288
    ds_read_b64_tr_b16 v[134:135], v201 offset:14624
    s_waitcnt lgkmcnt(10)
    v_mfma_f32_16x16x32_bf16 v[32:35], v[144:147], v[192:195], 0
    v_mfma_f32_16x16x32_bf16 v[36:39], v[144:147], v[196:199], 0
    ds_read_b64_tr_b16 v[136:137], v202 offset:320
    ds_read_b64_tr_b16 v[138:139], v202 offset:14656
    s_waitcnt lgkmcnt(10)
    v_mfma_f32_16x16x32_bf16 v[40:43], v[148:151], v[192:195], 0
    v_mfma_f32_16x16x32_bf16 v[44:47], v[148:151], v[196:199], 0
    ds_read_b64_tr_b16 v[140:141], v203 offset:352
    ds_read_b64_tr_b16 v[142:143], v203 offset:14688
    s_waitcnt lgkmcnt(10)
    v_mfma_f32_16x16x32_bf16 v[48:51], v[152:155], v[192:195], 0
    v_mfma_f32_16x16x32_bf16 v[52:55], v[152:155], v[196:199], 0
    ds_read_b64_tr_b16 v[144:145], v200 offset:384
    ds_read_b64_tr_b16 v[146:147], v200 offset:14720
    s_waitcnt lgkmcnt(10)
    v_mfma_f32_16x16x32_bf16 v[56:59], v[156:159], v[192:195], 0
    v_mfma_f32_16x16x32_bf16 v[60:63], v[156:159], v[196:199], 0
    ds_read_b64_tr_b16 v[148:149], v201 offset:416
    ds_read_b64_tr_b16 v[150:151], v201 offset:14752
    s_waitcnt lgkmcnt(10)
    v_mfma_f32_16x16x32_bf16 v[64:67], v[128:131], v[192:195], 0
    v_mfma_f32_16x16x32_bf16 v[68:71], v[128:131], v[196:199], 0
    s_waitcnt lgkmcnt(8)
    v_mfma_f32_16x16x32_bf16 v[72:75], v[132:135], v[192:195], 0
    v_mfma_f32_16x16x32_bf16 v[76:79], v[132:135], v[196:199], 0
    s_waitcnt lgkmcnt(6)
    v_mfma_f32_16x16x32_bf16 v[80:83], v[136:139], v[192:195], 0
    v_mfma_f32_16x16x32_bf16 v[84:87], v[136:139], v[196:199], 0
    s_waitcnt lgkmcnt(4)
    v_mfma_f32_16x16x32_bf16 v[88:91], v[140:143], v[192:195], 0
    v_mfma_f32_16x16x32_bf16 v[92:95], v[140:143], v[196:199], 0
    s_waitcnt lgkmcnt(2)
    v_mfma_f32_16x16x32_bf16 v[96:99], v[144:147], v[192:195], 0
    v_mfma_f32_16x16x32_bf16 v[100:103], v[144:147], v[196:199], 0
    s_waitcnt lgkmcnt(0)
    v_mfma_f32_16x16x32_bf16 v[104:107], v[148:151], v[192:195], 0
    v_mfma_f32_16x16x32_bf16 v[108:111], v[148:151], v[196:199], 0
    v_add_u32 v200, 32768, v200
    v_add_u32 v201, 32768, v201
    v_add_u32 v202, 32768, v202
    v_add_u32 v203, 32768, v203
    s_lshr_b32 s60, s96, 3
    s_lshl_b32 s60, s60, 15
    s_and_b32 s61, s96, 7
    s_lshl_b32 s61, s61, 11
    s_add_u32 s60, s60, s61
    v_add_u32 v233, s60, v232
    s_add_u32 s96, s96, 1
    s_and_b32 s96, s96, 15
    s_barrier
    ds_read_b128 v[192:195], v233 offset:0
    ds_read_b128 v[196:199], v233 offset:1024
    ds_read_b64_tr_b16 v[128:129], v200 offset:0
    ds_read_b64_tr_b16 v[130:131], v200 offset:14336
    ds_read_b64_tr_b16 v[132:133], v201 offset:32
    ds_read_b64_tr_b16 v[134:135], v201 offset:14368
    ds_read_b64_tr_b16 v[136:137], v202 offset:64
    ds_read_b64_tr_b16 v[138:139], v202 offset:14400
    ds_read_b64_tr_b16 v[140:141], v203 offset:96
    ds_read_b64_tr_b16 v[142:143], v203 offset:14432
    ds_read_b64_tr_b16 v[144:145], v200 offset:128
    ds_read_b64_tr_b16 v[146:147], v200 offset:14464
    ds_read_b64_tr_b16 v[148:149], v201 offset:160
    ds_read_b64_tr_b16 v[150:151], v201 offset:14496
    s_waitcnt lgkmcnt(10)
    v_mfma_f32_16x16x32_bf16 v[0:3], v[128:131], v[192:195], v[0:3]
    v_mfma_f32_16x16x32_bf16 v[4:7], v[128:131], v[196:199], v[4:7]
    ds_read_b64_tr_b16 v[152:153], v202 offset:192
    ds_read_b64_tr_b16 v[154:155], v202 offset:14528
    s_waitcnt lgkmcnt(10)
    v_mfma_f32_16x16x32_bf16 v[8:11], v[132:135], v[192:195], v[8:11]
    v_mfma_f32_16x16x32_bf16 v[12:15], v[132:135], v[196:199], v[12:15]
    ds_read_b64_tr_b16 v[156:157], v203 offset:224
    ds_read_b64_tr_b16 v[158:159], v203 offset:14560
    s_waitcnt lgkmcnt(10)
    v_mfma_f32_16x16x32_bf16 v[16:19], v[136:139], v[192:195], v[16:19]
    v_mfma_f32_16x16x32_bf16 v[20:23], v[136:139], v[196:199], v[20:23]
    ds_read_b64_tr_b16 v[128:129], v200 offset:256
    ds_read_b64_tr_b16 v[130:131], v200 offset:14592
    s_waitcnt lgkmcnt(10)
    v_mfma_f32_16x16x32_bf16 v[24:27], v[140:143], v[192:195], v[24:27]
    v_mfma_f32_16x16x32_bf16 v[28:31], v[140:143], v[196:199], v[28:31]
    ds_read_b64_tr_b16 v[132:133], v201 offset:288
    ds_read_b64_tr_b16 v[134:135], v201 offset:14624
    s_waitcnt lgkmcnt(10)
    v_mfma_f32_16x16x32_bf16 v[32:35], v[144:147], v[192:195], v[32:35]
    v_mfma_f32_16x16x32_bf16 v[36:39], v[144:147], v[196:199], v[36:39]
    ds_read_b64_tr_b16 v[136:137], v202 offset:320
    ds_read_b64_tr_b16 v[138:139], v202 offset:14656
    s_waitcnt lgkmcnt(10)
    v_mfma_f32_16x16x32_bf16 v[40:43], v[148:151], v[192:195], v[40:43]
    v_mfma_f32_16x16x32_bf16 v[44:47], v[148:151], v[196:199], v[44:47]
    ds_read_b64_tr_b16 v[140:141], v203 offset:352
    ds_read_b64_tr_b16 v[142:143], v203 offset:14688
    s_waitcnt lgkmcnt(10)
    v_mfma_f32_16x16x32_bf16 v[48:51], v[152:155], v[192:195], v[48:51]
    v_mfma_f32_16x16x32_bf16 v[52:55], v[152:155], v[196:199], v[52:55]
    ds_read_b64_tr_b16 v[144:145], v200 offset:384
    ds_read_b64_tr_b16 v[146:147], v200 offset:14720
    s_waitcnt lgkmcnt(10)
    v_mfma_f32_16x16x32_bf16 v[56:59], v[156:159], v[192:195], v[56:59]
    v_mfma_f32_16x16x32_bf16 v[60:63], v[156:159], v[196:199], v[60:63]
    ds_read_b64_tr_b16 v[148:149], v201 offset:416
    ds_read_b64_tr_b16 v[150:151], v201 offset:14752
    s_waitcnt lgkmcnt(10)
    v_mfma_f32_16x16x32_bf16 v[64:67], v[128:131], v[192:195], v[64:67]
    v_mfma_f32_16x16x32_bf16 v[68:71], v[128:131], v[196:199], v[68:71]
    s_waitcnt lgkmcnt(8)
    v_mfma_f32_16x16x32_bf16 v[72:75], v[132:135], v[192:195], v[72:75]
    v_mfma_f32_16x16x32_bf16 v[76:79], v[132:135], v[196:199], v[76:79]
    s_waitcnt lgkmcnt(6)
    v_mfma_f32_16x16x32_bf16 v[80:83], v[136:139], v[192:195], v[80:83]
    v_mfma_f32_16x16x32_bf16 v[84:87], v[136:139], v[196:199], v[84:87]
    s_waitcnt lgkmcnt(4)
    v_mfma_f32_16x16x32_bf16 v[88:91], v[140:143], v[192:195], v[88:91]
    v_mfma_f32_16x16x32_bf16 v[92:95], v[140:143], v[196:199], v[92:95]
    s_waitcnt lgkmcnt(2)
    v_mfma_f32_16x16x32_bf16 v[96:99], v[144:147], v[192:195], v[96:99]
    v_mfma_f32_16x16x32_bf16 v[100:103], v[144:147], v[196:199], v[100:103]
    s_waitcnt lgkmcnt(0)
    v_mfma_f32_16x16x32_bf16 v[104:107], v[148:151], v[192:195], v[104:107]
    v_mfma_f32_16x16x32_bf16 v[108:111], v[148:151], v[196:199], v[108:111]
    v_add_u32 v200, 4294901760, v200
    v_add_u32 v201, 4294901760, v201
    v_add_u32 v202, 4294901760, v202
    v_add_u32 v203, 4294901760, v203
    s_lshr_b32 s60, s96, 3
    s_lshl_b32 s60, s60, 15
    s_and_b32 s61, s96, 7
    s_lshl_b32 s61, s61, 11
    s_add_u32 s60, s60, s61
    v_add_u32 v233, s60, v232
    s_add_u32 s96, s96, 1
    s_and_b32 s96, s96, 15
    s_barrier
    ds_read_b128 v[192:195], v233 offset:0
    ds_read_b128 v[196:199], v233 offset:1024
    ds_read_b64_tr_b16 v[128:129], v200 offset:0
    ds_read_b64_tr_b16 v[130:131], v200 offset:14336
    ds_read_b64_tr_b16 v[132:133], v201 offset:32
    ds_read_b64_tr_b16 v[134:135], v201 offset:14368
    ds_read_b64_tr_b16 v[136:137], v202 offset:64
    ds_read_b64_tr_b16 v[138:139], v202 offset:14400
    ds_read_b64_tr_b16 v[140:141], v203 offset:96
    ds_read_b64_tr_b16 v[142:143], v203 offset:14432
    ds_read_b64_tr_b16 v[144:145], v200 offset:128
    ds_read_b64_tr_b16 v[146:147], v200 offset:14464
    ds_read_b64_tr_b16 v[148:149], v201 offset:160
    ds_read_b64_tr_b16 v[150:151], v201 offset:14496
    s_waitcnt lgkmcnt(10)
    v_mfma_f32_16x16x32_bf16 v[0:3], v[128:131], v[192:195], v[0:3]
    v_mfma_f32_16x16x32_bf16 v[4:7], v[128:131], v[196:199], v[4:7]
    ds_read_b64_tr_b16 v[152:153], v202 offset:192
    ds_read_b64_tr_b16 v[154:155], v202 offset:14528
    s_waitcnt lgkmcnt(10)
    v_mfma_f32_16x16x32_bf16 v[8:11], v[132:135], v[192:195], v[8:11]
    v_mfma_f32_16x16x32_bf16 v[12:15], v[132:135], v[196:199], v[12:15]
    ds_read_b64_tr_b16 v[156:157], v203 offset:224
    ds_read_b64_tr_b16 v[158:159], v203 offset:14560
    s_waitcnt lgkmcnt(10)
    v_mfma_f32_16x16x32_bf16 v[16:19], v[136:139], v[192:195], v[16:19]
    v_mfma_f32_16x16x32_bf16 v[20:23], v[136:139], v[196:199], v[20:23]
    ds_read_b64_tr_b16 v[128:129], v200 offset:256
    ds_read_b64_tr_b16 v[130:131], v200 offset:14592
    s_waitcnt lgkmcnt(10)
    v_mfma_f32_16x16x32_bf16 v[24:27], v[140:143], v[192:195], v[24:27]
    v_mfma_f32_16x16x32_bf16 v[28:31], v[140:143], v[196:199], v[28:31]
    ds_read_b64_tr_b16 v[132:133], v201 offset:288
    ds_read_b64_tr_b16 v[134:135], v201 offset:14624
    s_waitcnt lgkmcnt(10)
    v_mfma_f32_16x16x32_bf16 v[32:35], v[144:147], v[192:195], v[32:35]
    v_mfma_f32_16x16x32_bf16 v[36:39], v[144:147], v[196:199], v[36:39]
    ds_read_b64_tr_b16 v[136:137], v202 offset:320
    ds_read_b64_tr_b16 v[138:139], v202 offset:14656
    s_waitcnt lgkmcnt(10)
    v_mfma_f32_16x16x32_bf16 v[40:43], v[148:151], v[192:195], v[40:43]
    v_mfma_f32_16x16x32_bf16 v[44:47], v[148:151], v[196:199], v[44:47]
    ds_read_b64_tr_b16 v[140:141], v203 offset:352
    ds_read_b64_tr_b16 v[142:143], v203 offset:14688
    s_waitcnt lgkmcnt(10)
    v_mfma_f32_16x16x32_bf16 v[48:51], v[152:155], v[192:195], v[48:51]
    v_mfma_f32_16x16x32_bf16 v[52:55], v[152:155], v[196:199], v[52:55]
    ds_read_b64_tr_b16 v[144:145], v200 offset:384
    ds_read_b64_tr_b16 v[146:147], v200 offset:14720
    s_waitcnt lgkmcnt(10)
    v_mfma_f32_16x16x32_bf16 v[56:59], v[156:159], v[192:195], v[56:59]
    v_mfma_f32_16x16x32_bf16 v[60:63], v[156:159], v[196:199], v[60:63]
    ds_read_b64_tr_b16 v[148:149], v201 offset:416
    ds_read_b64_tr_b16 v[150:151], v201 offset:14752
    s_waitcnt lgkmcnt(10)
    v_mfma_f32_16x16x32_bf16 v[64:67], v[128:131], v[192:195], v[64:67]
    v_mfma_f32_16x16x32_bf16 v[68:71], v[128:131], v[196:199], v[68:71]
    s_waitcnt lgkmcnt(8)
    v_mfma_f32_16x16x32_bf16 v[72:75], v[132:135], v[192:195], v[72:75]
    v_mfma_f32_16x16x32_bf16 v[76:79], v[132:135], v[196:199], v[76:79]
    s_waitcnt lgkmcnt(6)
    v_mfma_f32_16x16x32_bf16 v[80:83], v[136:139], v[192:195], v[80:83]
    v_mfma_f32_16x16x32_bf16 v[84:87], v[136:139], v[196:199], v[84:87]
    s_waitcnt lgkmcnt(4)
    v_mfma_f32_16x16x32_bf16 v[88:91], v[140:143], v[192:195], v[88:91]
    v_mfma_f32_16x16x32_bf16 v[92:95], v[140:143], v[196:199], v[92:95]
    s_waitcnt lgkmcnt(2)
    v_mfma_f32_16x16x32_bf16 v[96:99], v[144:147], v[192:195], v[96:99]
    v_mfma_f32_16x16x32_bf16 v[100:103], v[144:147], v[196:199], v[100:103]
    s_waitcnt lgkmcnt(0)
    v_mfma_f32_16x16x32_bf16 v[104:107], v[148:151], v[192:195], v[104:107]
    v_mfma_f32_16x16x32_bf16 v[108:111], v[148:151], v[196:199], v[108:111]
    v_add_u32 v200, 32768, v200
    v_add_u32 v201, 32768, v201
    v_add_u32 v202, 32768, v202
    v_add_u32 v203, 32768, v203
    s_lshr_b32 s60, s96, 3
    s_lshl_b32 s60, s60, 15
    s_and_b32 s61, s96, 7
    s_lshl_b32 s61, s61, 11
    s_add_u32 s60, s60, s61
    v_add_u32 v233, s60, v232
    s_add_u32 s96, s96, 1
    s_and_b32 s96, s96, 15
    s_barrier
    ds_read_b128 v[192:195], v233 offset:0
    ds_read_b128 v[196:199], v233 offset:1024
    ds_read_b64_tr_b16 v[128:129], v200 offset:0
    ds_read_b64_tr_b16 v[130:131], v200 offset:14336
    ds_read_b64_tr_b16 v[132:133], v201 offset:32
    ds_read_b64_tr_b16 v[134:135], v201 offset:14368
    ds_read_b64_tr_b16 v[136:137], v202 offset:64
    ds_read_b64_tr_b16 v[138:139], v202 offset:14400
    ds_read_b64_tr_b16 v[140:141], v203 offset:96
    ds_read_b64_tr_b16 v[142:143], v203 offset:14432
    ds_read_b64_tr_b16 v[144:145], v200 offset:128
    ds_read_b64_tr_b16 v[146:147], v200 offset:14464
    ds_read_b64_tr_b16 v[148:149], v201 offset:160
    ds_read_b64_tr_b16 v[150:151], v201 offset:14496
    s_waitcnt lgkmcnt(10)
    v_mfma_f32_16x16x32_bf16 v[0:3], v[128:131], v[192:195], v[0:3]
    v_mfma_f32_16x16x32_bf16 v[4:7], v[128:131], v[196:199], v[4:7]
    ds_read_b64_tr_b16 v[152:153], v202 offset:192
    ds_read_b64_tr_b16 v[154:155], v202 offset:14528
    s_waitcnt lgkmcnt(10)
    v_mfma_f32_16x16x32_bf16 v[8:11], v[132:135], v[192:195], v[8:11]
    v_mfma_f32_16x16x32_bf16 v[12:15], v[132:135], v[196:199], v[12:15]
    ds_read_b64_tr_b16 v[156:157], v203 offset:224
    ds_read_b64_tr_b16 v[158:159], v203 offset:14560
    s_waitcnt lgkmcnt(10)
    v_mfma_f32_16x16x32_bf16 v[16:19], v[136:139], v[192:195], v[16:19]
    v_mfma_f32_16x16x32_bf16 v[20:23], v[136:139], v[196:199], v[20:23]
    ds_read_b64_tr_b16 v[128:129], v200 offset:256
    ds_read_b64_tr_b16 v[130:131], v200 offset:14592
    s_waitcnt lgkmcnt(10)
    v_mfma_f32_16x16x32_bf16 v[24:27], v[140:143], v[192:195], v[24:27]
    v_mfma_f32_16x16x32_bf16 v[28:31], v[140:143], v[196:199], v[28:31]
    ds_read_b64_tr_b16 v[132:133], v201 offset:288
    ds_read_b64_tr_b16 v[134:135], v201 offset:14624
    s_waitcnt lgkmcnt(10)
    v_mfma_f32_16x16x32_bf16 v[32:35], v[144:147], v[192:195], v[32:35]
    v_mfma_f32_16x16x32_bf16 v[36:39], v[144:147], v[196:199], v[36:39]
    ds_read_b64_tr_b16 v[136:137], v202 offset:320
    ds_read_b64_tr_b16 v[138:139], v202 offset:14656
    s_waitcnt lgkmcnt(10)
    v_mfma_f32_16x16x32_bf16 v[40:43], v[148:151], v[192:195], v[40:43]
    v_mfma_f32_16x16x32_bf16 v[44:47], v[148:151], v[196:199], v[44:47]
    ds_read_b64_tr_b16 v[140:141], v203 offset:352
    ds_read_b64_tr_b16 v[142:143], v203 offset:14688
    s_waitcnt lgkmcnt(10)
    v_mfma_f32_16x16x32_bf16 v[48:51], v[152:155], v[192:195], v[48:51]
    v_mfma_f32_16x16x32_bf16 v[52:55], v[152:155], v[196:199], v[52:55]
    ds_read_b64_tr_b16 v[144:145], v200 offset:384
    ds_read_b64_tr_b16 v[146:147], v200 offset:14720
    s_waitcnt lgkmcnt(10)
    v_mfma_f32_16x16x32_bf16 v[56:59], v[156:159], v[192:195], v[56:59]
    v_mfma_f32_16x16x32_bf16 v[60:63], v[156:159], v[196:199], v[60:63]
    ds_read_b64_tr_b16 v[148:149], v201 offset:416
    ds_read_b64_tr_b16 v[150:151], v201 offset:14752
    s_waitcnt lgkmcnt(10)
    v_mfma_f32_16x16x32_bf16 v[64:67], v[128:131], v[192:195], v[64:67]
    v_mfma_f32_16x16x32_bf16 v[68:71], v[128:131], v[196:199], v[68:71]
    s_waitcnt lgkmcnt(8)
    v_mfma_f32_16x16x32_bf16 v[72:75], v[132:135], v[192:195], v[72:75]
    v_mfma_f32_16x16x32_bf16 v[76:79], v[132:135], v[196:199], v[76:79]
    s_waitcnt lgkmcnt(6)
    v_mfma_f32_16x16x32_bf16 v[80:83], v[136:139], v[192:195], v[80:83]
    v_mfma_f32_16x16x32_bf16 v[84:87], v[136:139], v[196:199], v[84:87]
    s_waitcnt lgkmcnt(4)
    v_mfma_f32_16x16x32_bf16 v[88:91], v[140:143], v[192:195], v[88:91]
    v_mfma_f32_16x16x32_bf16 v[92:95], v[140:143], v[196:199], v[92:95]
    s_waitcnt lgkmcnt(2)
    v_mfma_f32_16x16x32_bf16 v[96:99], v[144:147], v[192:195], v[96:99]
    v_mfma_f32_16x16x32_bf16 v[100:103], v[144:147], v[196:199], v[100:103]
    s_waitcnt lgkmcnt(0)
    v_mfma_f32_16x16x32_bf16 v[104:107], v[148:151], v[192:195], v[104:107]
    v_mfma_f32_16x16x32_bf16 v[108:111], v[148:151], v[196:199], v[108:111]
    v_add_u32 v200, 32768, v200
    v_add_u32 v201, 32768, v201
    v_add_u32 v202, 32768, v202
    v_add_u32 v203, 32768, v203
    s_lshr_b32 s60, s96, 3
    s_lshl_b32 s60, s60, 15
    s_and_b32 s61, s96, 7
    s_lshl_b32 s61, s61, 11
    s_add_u32 s60, s60, s61
    v_add_u32 v233, s60, v232
    s_add_u32 s96, s96, 1
    s_and_b32 s96, s96, 15
    s_barrier
    ds_read_b128 v[192:195], v233 offset:0
    ds_read_b128 v[196:199], v233 offset:1024
    ds_read_b64_tr_b16 v[128:129], v200 offset:0
    ds_read_b64_tr_b16 v[130:131], v200 offset:14336
    ds_read_b64_tr_b16 v[132:133], v201 offset:32
    ds_read_b64_tr_b16 v[134:135], v201 offset:14368
    ds_read_b64_tr_b16 v[136:137], v202 offset:64
    ds_read_b64_tr_b16 v[138:139], v202 offset:14400
    ds_read_b64_tr_b16 v[140:141], v203 offset:96
    ds_read_b64_tr_b16 v[142:143], v203 offset:14432
    ds_read_b64_tr_b16 v[144:145], v200 offset:128
    ds_read_b64_tr_b16 v[146:147], v200 offset:14464
    ds_read_b64_tr_b16 v[148:149], v201 offset:160
    ds_read_b64_tr_b16 v[150:151], v201 offset:14496
    s_waitcnt lgkmcnt(10)
    v_mfma_f32_16x16x32_bf16 v[0:3], v[128:131], v[192:195], v[0:3]
    v_mfma_f32_16x16x32_bf16 v[4:7], v[128:131], v[196:199], v[4:7]
    ds_read_b64_tr_b16 v[152:153], v202 offset:192
    ds_read_b64_tr_b16 v[154:155], v202 offset:14528
    s_waitcnt lgkmcnt(10)
    v_mfma_f32_16x16x32_bf16 v[8:11], v[132:135], v[192:195], v[8:11]
    v_mfma_f32_16x16x32_bf16 v[12:15], v[132:135], v[196:199], v[12:15]
    ds_read_b64_tr_b16 v[156:157], v203 offset:224
    ds_read_b64_tr_b16 v[158:159], v203 offset:14560
    s_waitcnt lgkmcnt(10)
    v_mfma_f32_16x16x32_bf16 v[16:19], v[136:139], v[192:195], v[16:19]
    v_mfma_f32_16x16x32_bf16 v[20:23], v[136:139], v[196:199], v[20:23]
    ds_read_b64_tr_b16 v[128:129], v200 offset:256
    ds_read_b64_tr_b16 v[130:131], v200 offset:14592
    s_waitcnt lgkmcnt(10)
    v_mfma_f32_16x16x32_bf16 v[24:27], v[140:143], v[192:195], v[24:27]
    v_mfma_f32_16x16x32_bf16 v[28:31], v[140:143], v[196:199], v[28:31]
    ds_read_b64_tr_b16 v[132:133], v201 offset:288
    ds_read_b64_tr_b16 v[134:135], v201 offset:14624
    s_waitcnt lgkmcnt(10)
    v_mfma_f32_16x16x32_bf16 v[32:35], v[144:147], v[192:195], v[32:35]
    v_mfma_f32_16x16x32_bf16 v[36:39], v[144:147], v[196:199], v[36:39]
    ds_read_b64_tr_b16 v[136:137], v202 offset:320
    ds_read_b64_tr_b16 v[138:139], v202 offset:14656
    s_waitcnt lgkmcnt(10)
    v_mfma_f32_16x16x32_bf16 v[40:43], v[148:151], v[192:195], v[40:43]
    v_mfma_f32_16x16x32_bf16 v[44:47], v[148:151], v[196:199], v[44:47]
    ds_read_b64_tr_b16 v[140:141], v203 offset:352
    ds_read_b64_tr_b16 v[142:143], v203 offset:14688
    s_waitcnt lgkmcnt(10)
    v_mfma_f32_16x16x32_bf16 v[48:51], v[152:155], v[192:195], v[48:51]
    v_mfma_f32_16x16x32_bf16 v[52:55], v[152:155], v[196:199], v[52:55]
    ds_read_b64_tr_b16 v[144:145], v200 offset:384
    ds_read_b64_tr_b16 v[146:147], v200 offset:14720
    s_waitcnt lgkmcnt(10)
    v_mfma_f32_16x16x32_bf16 v[56:59], v[156:159], v[192:195], v[56:59]
    v_mfma_f32_16x16x32_bf16 v[60:63], v[156:159], v[196:199], v[60:63]
    ds_read_b64_tr_b16 v[148:149], v201 offset:416
    ds_read_b64_tr_b16 v[150:151], v201 offset:14752
    s_waitcnt lgkmcnt(10)
    v_mfma_f32_16x16x32_bf16 v[64:67], v[128:131], v[192:195], v[64:67]
    v_mfma_f32_16x16x32_bf16 v[68:71], v[128:131], v[196:199], v[68:71]
    s_waitcnt lgkmcnt(8)
    v_mfma_f32_16x16x32_bf16 v[72:75], v[132:135], v[192:195], v[72:75]
    v_mfma_f32_16x16x32_bf16 v[76:79], v[132:135], v[196:199], v[76:79]
    s_waitcnt lgkmcnt(6)
    v_mfma_f32_16x16x32_bf16 v[80:83], v[136:139], v[192:195], v[80:83]
    v_mfma_f32_16x16x32_bf16 v[84:87], v[136:139], v[196:199], v[84:87]
    s_waitcnt lgkmcnt(4)
    v_mfma_f32_16x16x32_bf16 v[88:91], v[140:143], v[192:195], v[88:91]
    v_mfma_f32_16x16x32_bf16 v[92:95], v[140:143], v[196:199], v[92:95]
    s_waitcnt lgkmcnt(2)
    v_mfma_f32_16x16x32_bf16 v[96:99], v[144:147], v[192:195], v[96:99]
    v_mfma_f32_16x16x32_bf16 v[100:103], v[144:147], v[196:199], v[100:103]
    s_waitcnt lgkmcnt(0)
    v_mfma_f32_16x16x32_bf16 v[104:107], v[148:151], v[192:195], v[104:107]
    v_mfma_f32_16x16x32_bf16 v[108:111], v[148:151], v[196:199], v[108:111]
    v_add_u32 v200, 4294901760, v200
    v_add_u32 v201, 4294901760, v201
    v_add_u32 v202, 4294901760, v202
    v_add_u32 v203, 4294901760, v203
    s_lshr_b32 s60, s96, 3
    s_lshl_b32 s60, s60, 15
    s_and_b32 s61, s96, 7
    s_lshl_b32 s61, s61, 11
    s_add_u32 s60, s60, s61
    v_add_u32 v233, s60, v232
    s_add_u32 s96, s96, 1
    s_and_b32 s96, s96, 15
    s_barrier
    ds_read_b128 v[192:195], v233 offset:0
    ds_read_b128 v[196:199], v233 offset:1024
    ds_read_b64_tr_b16 v[128:129], v200 offset:0
    ds_read_b64_tr_b16 v[130:131], v200 offset:14336
    ds_read_b64_tr_b16 v[132:133], v201 offset:32
    ds_read_b64_tr_b16 v[134:135], v201 offset:14368
    ds_read_b64_tr_b16 v[136:137], v202 offset:64
    ds_read_b64_tr_b16 v[138:139], v202 offset:14400
    ds_read_b64_tr_b16 v[140:141], v203 offset:96
    ds_read_b64_tr_b16 v[142:143], v203 offset:14432
    ds_read_b64_tr_b16 v[144:145], v200 offset:128
    ds_read_b64_tr_b16 v[146:147], v200 offset:14464
    ds_read_b64_tr_b16 v[148:149], v201 offset:160
    ds_read_b64_tr_b16 v[150:151], v201 offset:14496
    s_waitcnt lgkmcnt(10)
    v_mfma_f32_16x16x32_bf16 v[0:3], v[128:131], v[192:195], v[0:3]
    v_mfma_f32_16x16x32_bf16 v[4:7], v[128:131], v[196:199], v[4:7]
    ds_read_b64_tr_b16 v[152:153], v202 offset:192
    ds_read_b64_tr_b16 v[154:155], v202 offset:14528
    s_waitcnt lgkmcnt(10)
    v_mfma_f32_16x16x32_bf16 v[8:11], v[132:135], v[192:195], v[8:11]
    v_mfma_f32_16x16x32_bf16 v[12:15], v[132:135], v[196:199], v[12:15]
    ds_read_b64_tr_b16 v[156:157], v203 offset:224
    ds_read_b64_tr_b16 v[158:159], v203 offset:14560
    s_waitcnt lgkmcnt(10)
    v_mfma_f32_16x16x32_bf16 v[16:19], v[136:139], v[192:195], v[16:19]
    v_mfma_f32_16x16x32_bf16 v[20:23], v[136:139], v[196:199], v[20:23]
    ds_read_b64_tr_b16 v[128:129], v200 offset:256
    ds_read_b64_tr_b16 v[130:131], v200 offset:14592
    s_waitcnt lgkmcnt(10)
    v_mfma_f32_16x16x32_bf16 v[24:27], v[140:143], v[192:195], v[24:27]
    v_mfma_f32_16x16x32_bf16 v[28:31], v[140:143], v[196:199], v[28:31]
    ds_read_b64_tr_b16 v[132:133], v201 offset:288
    ds_read_b64_tr_b16 v[134:135], v201 offset:14624
    s_waitcnt lgkmcnt(10)
    v_mfma_f32_16x16x32_bf16 v[32:35], v[144:147], v[192:195], v[32:35]
    v_mfma_f32_16x16x32_bf16 v[36:39], v[144:147], v[196:199], v[36:39]
    ds_read_b64_tr_b16 v[136:137], v202 offset:320
    ds_read_b64_tr_b16 v[138:139], v202 offset:14656
    s_waitcnt lgkmcnt(10)
    v_mfma_f32_16x16x32_bf16 v[40:43], v[148:151], v[192:195], v[40:43]
    v_mfma_f32_16x16x32_bf16 v[44:47], v[148:151], v[196:199], v[44:47]
    ds_read_b64_tr_b16 v[140:141], v203 offset:352
    ds_read_b64_tr_b16 v[142:143], v203 offset:14688
    s_waitcnt lgkmcnt(10)
    v_mfma_f32_16x16x32_bf16 v[48:51], v[152:155], v[192:195], v[48:51]
    v_mfma_f32_16x16x32_bf16 v[52:55], v[152:155], v[196:199], v[52:55]
    ds_read_b64_tr_b16 v[144:145], v200 offset:384
    ds_read_b64_tr_b16 v[146:147], v200 offset:14720
    s_waitcnt lgkmcnt(10)
    v_mfma_f32_16x16x32_bf16 v[56:59], v[156:159], v[192:195], v[56:59]
    v_mfma_f32_16x16x32_bf16 v[60:63], v[156:159], v[196:199], v[60:63]
    ds_read_b64_tr_b16 v[148:149], v201 offset:416
    ds_read_b64_tr_b16 v[150:151], v201 offset:14752
    s_waitcnt lgkmcnt(10)
    v_mfma_f32_16x16x32_bf16 v[64:67], v[128:131], v[192:195], v[64:67]
    v_mfma_f32_16x16x32_bf16 v[68:71], v[128:131], v[196:199], v[68:71]
    s_waitcnt lgkmcnt(8)
    v_mfma_f32_16x16x32_bf16 v[72:75], v[132:135], v[192:195], v[72:75]
    v_mfma_f32_16x16x32_bf16 v[76:79], v[132:135], v[196:199], v[76:79]
    s_waitcnt lgkmcnt(6)
    v_mfma_f32_16x16x32_bf16 v[80:83], v[136:139], v[192:195], v[80:83]
    v_mfma_f32_16x16x32_bf16 v[84:87], v[136:139], v[196:199], v[84:87]
    s_waitcnt lgkmcnt(4)
    v_mfma_f32_16x16x32_bf16 v[88:91], v[140:143], v[192:195], v[88:91]
    v_mfma_f32_16x16x32_bf16 v[92:95], v[140:143], v[196:199], v[92:95]
    s_waitcnt lgkmcnt(2)
    v_mfma_f32_16x16x32_bf16 v[96:99], v[144:147], v[192:195], v[96:99]
    v_mfma_f32_16x16x32_bf16 v[100:103], v[144:147], v[196:199], v[100:103]
    s_waitcnt lgkmcnt(0)
    v_mfma_f32_16x16x32_bf16 v[104:107], v[148:151], v[192:195], v[104:107]
    v_mfma_f32_16x16x32_bf16 v[108:111], v[148:151], v[196:199], v[108:111]
    v_add_u32 v200, 32768, v200
    v_add_u32 v201, 32768, v201
    v_add_u32 v202, 32768, v202
    v_add_u32 v203, 32768, v203
    s_lshr_b32 s60, s96, 3
    s_lshl_b32 s60, s60, 15
    s_and_b32 s61, s96, 7
    s_lshl_b32 s61, s61, 11
    s_add_u32 s60, s60, s61
    v_add_u32 v233, s60, v232
    s_add_u32 s96, s96, 1
    s_and_b32 s96, s96, 15
    s_barrier
    ds_read_b128 v[192:195], v233 offset:0
    ds_read_b128 v[196:199], v233 offset:1024
    ds_read_b64_tr_b16 v[128:129], v200 offset:0
    ds_read_b64_tr_b16 v[130:131], v200 offset:14336
    ds_read_b64_tr_b16 v[132:133], v201 offset:32
    ds_read_b64_tr_b16 v[134:135], v201 offset:14368
    ds_read_b64_tr_b16 v[136:137], v202 offset:64
    ds_read_b64_tr_b16 v[138:139], v202 offset:14400
    ds_read_b64_tr_b16 v[140:141], v203 offset:96
    ds_read_b64_tr_b16 v[142:143], v203 offset:14432
    ds_read_b64_tr_b16 v[144:145], v200 offset:128
    ds_read_b64_tr_b16 v[146:147], v200 offset:14464
    ds_read_b64_tr_b16 v[148:149], v201 offset:160
    ds_read_b64_tr_b16 v[150:151], v201 offset:14496
    s_waitcnt lgkmcnt(10)
    v_mfma_f32_16x16x32_bf16 v[0:3], v[128:131], v[192:195], v[0:3]
    v_mfma_f32_16x16x32_bf16 v[4:7], v[128:131], v[196:199], v[4:7]
    ds_read_b64_tr_b16 v[152:153], v202 offset:192
    ds_read_b64_tr_b16 v[154:155], v202 offset:14528
    s_waitcnt lgkmcnt(10)
    v_mfma_f32_16x16x32_bf16 v[8:11], v[132:135], v[192:195], v[8:11]
    v_mfma_f32_16x16x32_bf16 v[12:15], v[132:135], v[196:199], v[12:15]
    ds_read_b64_tr_b16 v[156:157], v203 offset:224
    ds_read_b64_tr_b16 v[158:159], v203 offset:14560
    s_waitcnt lgkmcnt(10)
    v_mfma_f32_16x16x32_bf16 v[16:19], v[136:139], v[192:195], v[16:19]
    v_mfma_f32_16x16x32_bf16 v[20:23], v[136:139], v[196:199], v[20:23]
    ds_read_b64_tr_b16 v[128:129], v200 offset:256
    ds_read_b64_tr_b16 v[130:131], v200 offset:14592
    s_waitcnt lgkmcnt(10)
    v_mfma_f32_16x16x32_bf16 v[24:27], v[140:143], v[192:195], v[24:27]
    v_mfma_f32_16x16x32_bf16 v[28:31], v[140:143], v[196:199], v[28:31]
    ds_read_b64_tr_b16 v[132:133], v201 offset:288
    ds_read_b64_tr_b16 v[134:135], v201 offset:14624
    s_waitcnt lgkmcnt(10)
    v_mfma_f32_16x16x32_bf16 v[32:35], v[144:147], v[192:195], v[32:35]
    v_mfma_f32_16x16x32_bf16 v[36:39], v[144:147], v[196:199], v[36:39]
    ds_read_b64_tr_b16 v[136:137], v202 offset:320
    ds_read_b64_tr_b16 v[138:139], v202 offset:14656
    s_waitcnt lgkmcnt(10)
    v_mfma_f32_16x16x32_bf16 v[40:43], v[148:151], v[192:195], v[40:43]
    v_mfma_f32_16x16x32_bf16 v[44:47], v[148:151], v[196:199], v[44:47]
    ds_read_b64_tr_b16 v[140:141], v203 offset:352
    ds_read_b64_tr_b16 v[142:143], v203 offset:14688
    s_waitcnt lgkmcnt(10)
    v_mfma_f32_16x16x32_bf16 v[48:51], v[152:155], v[192:195], v[48:51]
    v_mfma_f32_16x16x32_bf16 v[52:55], v[152:155], v[196:199], v[52:55]
    ds_read_b64_tr_b16 v[144:145], v200 offset:384
    ds_read_b64_tr_b16 v[146:147], v200 offset:14720
    s_waitcnt lgkmcnt(10)
    v_mfma_f32_16x16x32_bf16 v[56:59], v[156:159], v[192:195], v[56:59]
    v_mfma_f32_16x16x32_bf16 v[60:63], v[156:159], v[196:199], v[60:63]
    ds_read_b64_tr_b16 v[148:149], v201 offset:416
    ds_read_b64_tr_b16 v[150:151], v201 offset:14752
    s_waitcnt lgkmcnt(10)
    v_mfma_f32_16x16x32_bf16 v[64:67], v[128:131], v[192:195], v[64:67]
    v_mfma_f32_16x16x32_bf16 v[68:71], v[128:131], v[196:199], v[68:71]
    s_waitcnt lgkmcnt(8)
    v_mfma_f32_16x16x32_bf16 v[72:75], v[132:135], v[192:195], v[72:75]
    v_mfma_f32_16x16x32_bf16 v[76:79], v[132:135], v[196:199], v[76:79]
    s_waitcnt lgkmcnt(6)
    v_mfma_f32_16x16x32_bf16 v[80:83], v[136:139], v[192:195], v[80:83]
    v_mfma_f32_16x16x32_bf16 v[84:87], v[136:139], v[196:199], v[84:87]
    s_waitcnt lgkmcnt(4)
    v_mfma_f32_16x16x32_bf16 v[88:91], v[140:143], v[192:195], v[88:91]
    v_mfma_f32_16x16x32_bf16 v[92:95], v[140:143], v[196:199], v[92:95]
    s_waitcnt lgkmcnt(2)
    v_mfma_f32_16x16x32_bf16 v[96:99], v[144:147], v[192:195], v[96:99]
    v_mfma_f32_16x16x32_bf16 v[100:103], v[144:147], v[196:199], v[100:103]
    s_waitcnt lgkmcnt(0)
    v_mfma_f32_16x16x32_bf16 v[104:107], v[148:151], v[192:195], v[104:107]
    v_mfma_f32_16x16x32_bf16 v[108:111], v[148:151], v[196:199], v[108:111]
    v_add_u32 v200, 32768, v200
    v_add_u32 v201, 32768, v201
    v_add_u32 v202, 32768, v202
    v_add_u32 v203, 32768, v203
    s_lshr_b32 s60, s96, 3
    s_lshl_b32 s60, s60, 15
    s_and_b32 s61, s96, 7
    s_lshl_b32 s61, s61, 11
    s_add_u32 s60, s60, s61
    v_add_u32 v233, s60, v232
    s_add_u32 s96, s96, 1
    s_and_b32 s96, s96, 15
    s_barrier
    ds_read_b128 v[192:195], v233 offset:0
    ds_read_b128 v[196:199], v233 offset:1024
    ds_read_b64_tr_b16 v[128:129], v200 offset:0
    ds_read_b64_tr_b16 v[130:131], v200 offset:14336
    ds_read_b64_tr_b16 v[132:133], v201 offset:32
    ds_read_b64_tr_b16 v[134:135], v201 offset:14368
    ds_read_b64_tr_b16 v[136:137], v202 offset:64
    ds_read_b64_tr_b16 v[138:139], v202 offset:14400
    ds_read_b64_tr_b16 v[140:141], v203 offset:96
    ds_read_b64_tr_b16 v[142:143], v203 offset:14432
    ds_read_b64_tr_b16 v[144:145], v200 offset:128
    ds_read_b64_tr_b16 v[146:147], v200 offset:14464
    ds_read_b64_tr_b16 v[148:149], v201 offset:160
    ds_read_b64_tr_b16 v[150:151], v201 offset:14496
    s_waitcnt lgkmcnt(10)
    v_mfma_f32_16x16x32_bf16 v[0:3], v[128:131], v[192:195], v[0:3]
    v_mfma_f32_16x16x32_bf16 v[4:7], v[128:131], v[196:199], v[4:7]
    ds_read_b64_tr_b16 v[152:153], v202 offset:192
    ds_read_b64_tr_b16 v[154:155], v202 offset:14528
    s_waitcnt lgkmcnt(10)
    v_mfma_f32_16x16x32_bf16 v[8:11], v[132:135], v[192:195], v[8:11]
    v_mfma_f32_16x16x32_bf16 v[12:15], v[132:135], v[196:199], v[12:15]
    ds_read_b64_tr_b16 v[156:157], v203 offset:224
    ds_read_b64_tr_b16 v[158:159], v203 offset:14560
    s_waitcnt lgkmcnt(10)
    v_mfma_f32_16x16x32_bf16 v[16:19], v[136:139], v[192:195], v[16:19]
    v_mfma_f32_16x16x32_bf16 v[20:23], v[136:139], v[196:199], v[20:23]
    ds_read_b64_tr_b16 v[128:129], v200 offset:256
    ds_read_b64_tr_b16 v[130:131], v200 offset:14592
    s_waitcnt lgkmcnt(10)
    v_mfma_f32_16x16x32_bf16 v[24:27], v[140:143], v[192:195], v[24:27]
    v_mfma_f32_16x16x32_bf16 v[28:31], v[140:143], v[196:199], v[28:31]
    ds_read_b64_tr_b16 v[132:133], v201 offset:288
    ds_read_b64_tr_b16 v[134:135], v201 offset:14624
    s_waitcnt lgkmcnt(10)
    v_mfma_f32_16x16x32_bf16 v[32:35], v[144:147], v[192:195], v[32:35]
    v_mfma_f32_16x16x32_bf16 v[36:39], v[144:147], v[196:199], v[36:39]
    ds_read_b64_tr_b16 v[136:137], v202 offset:320
    ds_read_b64_tr_b16 v[138:139], v202 offset:14656
    s_waitcnt lgkmcnt(10)
    v_mfma_f32_16x16x32_bf16 v[40:43], v[148:151], v[192:195], v[40:43]
    v_mfma_f32_16x16x32_bf16 v[44:47], v[148:151], v[196:199], v[44:47]
    ds_read_b64_tr_b16 v[140:141], v203 offset:352
    ds_read_b64_tr_b16 v[142:143], v203 offset:14688
    s_waitcnt lgkmcnt(10)
    v_mfma_f32_16x16x32_bf16 v[48:51], v[152:155], v[192:195], v[48:51]
    v_mfma_f32_16x16x32_bf16 v[52:55], v[152:155], v[196:199], v[52:55]
    ds_read_b64_tr_b16 v[144:145], v200 offset:384
    ds_read_b64_tr_b16 v[146:147], v200 offset:14720
    s_waitcnt lgkmcnt(10)
    v_mfma_f32_16x16x32_bf16 v[56:59], v[156:159], v[192:195], v[56:59]
    v_mfma_f32_16x16x32_bf16 v[60:63], v[156:159], v[196:199], v[60:63]
    ds_read_b64_tr_b16 v[148:149], v201 offset:416
    ds_read_b64_tr_b16 v[150:151], v201 offset:14752
    s_waitcnt lgkmcnt(10)
    v_mfma_f32_16x16x32_bf16 v[64:67], v[128:131], v[192:195], v[64:67]
    v_mfma_f32_16x16x32_bf16 v[68:71], v[128:131], v[196:199], v[68:71]
    s_waitcnt lgkmcnt(8)
    v_mfma_f32_16x16x32_bf16 v[72:75], v[132:135], v[192:195], v[72:75]
    v_mfma_f32_16x16x32_bf16 v[76:79], v[132:135], v[196:199], v[76:79]
    s_waitcnt lgkmcnt(6)
    v_mfma_f32_16x16x32_bf16 v[80:83], v[136:139], v[192:195], v[80:83]
    v_mfma_f32_16x16x32_bf16 v[84:87], v[136:139], v[196:199], v[84:87]
    s_waitcnt lgkmcnt(4)
    v_mfma_f32_16x16x32_bf16 v[88:91], v[140:143], v[192:195], v[88:91]
    v_mfma_f32_16x16x32_bf16 v[92:95], v[140:143], v[196:199], v[92:95]
    s_waitcnt lgkmcnt(2)
    v_mfma_f32_16x16x32_bf16 v[96:99], v[144:147], v[192:195], v[96:99]
    v_mfma_f32_16x16x32_bf16 v[100:103], v[144:147], v[196:199], v[100:103]
    s_waitcnt lgkmcnt(0)
    v_mfma_f32_16x16x32_bf16 v[104:107], v[148:151], v[192:195], v[104:107]
    v_mfma_f32_16x16x32_bf16 v[108:111], v[148:151], v[196:199], v[108:111]
    v_add_u32 v200, 4294901760, v200
    v_add_u32 v201, 4294901760, v201
    v_add_u32 v202, 4294901760, v202
    v_add_u32 v203, 4294901760, v203
    s_lshr_b32 s60, s96, 3
    s_lshl_b32 s60, s60, 15
    s_and_b32 s61, s96, 7
    s_lshl_b32 s61, s61, 11
    s_add_u32 s60, s60, s61
    v_add_u32 v233, s60, v232
    s_add_u32 s96, s96, 1
    s_and_b32 s96, s96, 15
    s_barrier
    ds_read_b128 v[192:195], v233 offset:0
    ds_read_b128 v[196:199], v233 offset:1024
    ds_read_b64_tr_b16 v[128:129], v200 offset:0
    ds_read_b64_tr_b16 v[130:131], v200 offset:14336
    ds_read_b64_tr_b16 v[132:133], v201 offset:32
    ds_read_b64_tr_b16 v[134:135], v201 offset:14368
    ds_read_b64_tr_b16 v[136:137], v202 offset:64
    ds_read_b64_tr_b16 v[138:139], v202 offset:14400
    ds_read_b64_tr_b16 v[140:141], v203 offset:96
    ds_read_b64_tr_b16 v[142:143], v203 offset:14432
    ds_read_b64_tr_b16 v[144:145], v200 offset:128
    ds_read_b64_tr_b16 v[146:147], v200 offset:14464
    ds_read_b64_tr_b16 v[148:149], v201 offset:160
    ds_read_b64_tr_b16 v[150:151], v201 offset:14496
    s_waitcnt lgkmcnt(10)
    v_mfma_f32_16x16x32_bf16 v[0:3], v[128:131], v[192:195], v[0:3]
    v_mfma_f32_16x16x32_bf16 v[4:7], v[128:131], v[196:199], v[4:7]
    ds_read_b64_tr_b16 v[152:153], v202 offset:192
    ds_read_b64_tr_b16 v[154:155], v202 offset:14528
    s_waitcnt lgkmcnt(10)
    v_mfma_f32_16x16x32_bf16 v[8:11], v[132:135], v[192:195], v[8:11]
    v_mfma_f32_16x16x32_bf16 v[12:15], v[132:135], v[196:199], v[12:15]
    ds_read_b64_tr_b16 v[156:157], v203 offset:224
    ds_read_b64_tr_b16 v[158:159], v203 offset:14560
    s_waitcnt lgkmcnt(10)
    v_mfma_f32_16x16x32_bf16 v[16:19], v[136:139], v[192:195], v[16:19]
    v_mfma_f32_16x16x32_bf16 v[20:23], v[136:139], v[196:199], v[20:23]
    ds_read_b64_tr_b16 v[128:129], v200 offset:256
    ds_read_b64_tr_b16 v[130:131], v200 offset:14592
    s_waitcnt lgkmcnt(10)
    v_mfma_f32_16x16x32_bf16 v[24:27], v[140:143], v[192:195], v[24:27]
    v_mfma_f32_16x16x32_bf16 v[28:31], v[140:143], v[196:199], v[28:31]
    ds_read_b64_tr_b16 v[132:133], v201 offset:288
    ds_read_b64_tr_b16 v[134:135], v201 offset:14624
    s_waitcnt lgkmcnt(10)
    v_mfma_f32_16x16x32_bf16 v[32:35], v[144:147], v[192:195], v[32:35]
    v_mfma_f32_16x16x32_bf16 v[36:39], v[144:147], v[196:199], v[36:39]
    ds_read_b64_tr_b16 v[136:137], v202 offset:320
    ds_read_b64_tr_b16 v[138:139], v202 offset:14656
    s_waitcnt lgkmcnt(10)
    v_mfma_f32_16x16x32_bf16 v[40:43], v[148:151], v[192:195], v[40:43]
    v_mfma_f32_16x16x32_bf16 v[44:47], v[148:151], v[196:199], v[44:47]
    ds_read_b64_tr_b16 v[140:141], v203 offset:352
    ds_read_b64_tr_b16 v[142:143], v203 offset:14688
    s_waitcnt lgkmcnt(10)
    v_mfma_f32_16x16x32_bf16 v[48:51], v[152:155], v[192:195], v[48:51]
    v_mfma_f32_16x16x32_bf16 v[52:55], v[152:155], v[196:199], v[52:55]
    ds_read_b64_tr_b16 v[144:145], v200 offset:384
    ds_read_b64_tr_b16 v[146:147], v200 offset:14720
    s_waitcnt lgkmcnt(10)
    v_mfma_f32_16x16x32_bf16 v[56:59], v[156:159], v[192:195], v[56:59]
    v_mfma_f32_16x16x32_bf16 v[60:63], v[156:159], v[196:199], v[60:63]
    ds_read_b64_tr_b16 v[148:149], v201 offset:416
    ds_read_b64_tr_b16 v[150:151], v201 offset:14752
    s_waitcnt lgkmcnt(10)
    v_mfma_f32_16x16x32_bf16 v[64:67], v[128:131], v[192:195], v[64:67]
    v_mfma_f32_16x16x32_bf16 v[68:71], v[128:131], v[196:199], v[68:71]
    s_waitcnt lgkmcnt(8)
    v_mfma_f32_16x16x32_bf16 v[72:75], v[132:135], v[192:195], v[72:75]
    v_mfma_f32_16x16x32_bf16 v[76:79], v[132:135], v[196:199], v[76:79]
    s_waitcnt lgkmcnt(6)
    v_mfma_f32_16x16x32_bf16 v[80:83], v[136:139], v[192:195], v[80:83]
    v_mfma_f32_16x16x32_bf16 v[84:87], v[136:139], v[196:199], v[84:87]
    s_waitcnt lgkmcnt(4)
    v_mfma_f32_16x16x32_bf16 v[88:91], v[140:143], v[192:195], v[88:91]
    v_mfma_f32_16x16x32_bf16 v[92:95], v[140:143], v[196:199], v[92:95]
    s_waitcnt lgkmcnt(2)
    v_mfma_f32_16x16x32_bf16 v[96:99], v[144:147], v[192:195], v[96:99]
    v_mfma_f32_16x16x32_bf16 v[100:103], v[144:147], v[196:199], v[100:103]
    s_waitcnt lgkmcnt(0)
    v_mfma_f32_16x16x32_bf16 v[104:107], v[148:151], v[192:195], v[104:107]
    v_mfma_f32_16x16x32_bf16 v[108:111], v[148:151], v[196:199], v[108:111]
    v_add_u32 v200, 32768, v200
    v_add_u32 v201, 32768, v201
    v_add_u32 v202, 32768, v202
    v_add_u32 v203, 32768, v203
    s_lshr_b32 s60, s96, 3
    s_lshl_b32 s60, s60, 15
    s_and_b32 s61, s96, 7
    s_lshl_b32 s61, s61, 11
    s_add_u32 s60, s60, s61
    v_add_u32 v233, s60, v232
    s_add_u32 s96, s96, 1
    s_and_b32 s96, s96, 15
    s_barrier
    ds_read_b128 v[192:195], v233 offset:0
    ds_read_b128 v[196:199], v233 offset:1024
    ds_read_b64_tr_b16 v[128:129], v200 offset:0
    ds_read_b64_tr_b16 v[130:131], v200 offset:14336
    ds_read_b64_tr_b16 v[132:133], v201 offset:32
    ds_read_b64_tr_b16 v[134:135], v201 offset:14368
    ds_read_b64_tr_b16 v[136:137], v202 offset:64
    ds_read_b64_tr_b16 v[138:139], v202 offset:14400
    ds_read_b64_tr_b16 v[140:141], v203 offset:96
    ds_read_b64_tr_b16 v[142:143], v203 offset:14432
    ds_read_b64_tr_b16 v[144:145], v200 offset:128
    ds_read_b64_tr_b16 v[146:147], v200 offset:14464
    ds_read_b64_tr_b16 v[148:149], v201 offset:160
    ds_read_b64_tr_b16 v[150:151], v201 offset:14496
    s_waitcnt lgkmcnt(10)
    v_mfma_f32_16x16x32_bf16 v[0:3], v[128:131], v[192:195], v[0:3]
    v_mfma_f32_16x16x32_bf16 v[4:7], v[128:131], v[196:199], v[4:7]
    ds_read_b64_tr_b16 v[152:153], v202 offset:192
    ds_read_b64_tr_b16 v[154:155], v202 offset:14528
    s_waitcnt lgkmcnt(10)
    v_mfma_f32_16x16x32_bf16 v[8:11], v[132:135], v[192:195], v[8:11]
    v_mfma_f32_16x16x32_bf16 v[12:15], v[132:135], v[196:199], v[12:15]
    ds_read_b64_tr_b16 v[156:157], v203 offset:224
    ds_read_b64_tr_b16 v[158:159], v203 offset:14560
    s_waitcnt lgkmcnt(10)
    v_mfma_f32_16x16x32_bf16 v[16:19], v[136:139], v[192:195], v[16:19]
    v_mfma_f32_16x16x32_bf16 v[20:23], v[136:139], v[196:199], v[20:23]
    ds_read_b64_tr_b16 v[128:129], v200 offset:256
    ds_read_b64_tr_b16 v[130:131], v200 offset:14592
    s_waitcnt lgkmcnt(10)
    v_mfma_f32_16x16x32_bf16 v[24:27], v[140:143], v[192:195], v[24:27]
    v_mfma_f32_16x16x32_bf16 v[28:31], v[140:143], v[196:199], v[28:31]
    ds_read_b64_tr_b16 v[132:133], v201 offset:288
    ds_read_b64_tr_b16 v[134:135], v201 offset:14624
    s_waitcnt lgkmcnt(10)
    v_mfma_f32_16x16x32_bf16 v[32:35], v[144:147], v[192:195], v[32:35]
    v_mfma_f32_16x16x32_bf16 v[36:39], v[144:147], v[196:199], v[36:39]
    ds_read_b64_tr_b16 v[136:137], v202 offset:320
    ds_read_b64_tr_b16 v[138:139], v202 offset:14656
    s_waitcnt lgkmcnt(10)
    v_mfma_f32_16x16x32_bf16 v[40:43], v[148:151], v[192:195], v[40:43]
    v_mfma_f32_16x16x32_bf16 v[44:47], v[148:151], v[196:199], v[44:47]
    ds_read_b64_tr_b16 v[140:141], v203 offset:352
    ds_read_b64_tr_b16 v[142:143], v203 offset:14688
    s_waitcnt lgkmcnt(10)
    v_mfma_f32_16x16x32_bf16 v[48:51], v[152:155], v[192:195], v[48:51]
    v_mfma_f32_16x16x32_bf16 v[52:55], v[152:155], v[196:199], v[52:55]
    ds_read_b64_tr_b16 v[144:145], v200 offset:384
    ds_read_b64_tr_b16 v[146:147], v200 offset:14720
    s_waitcnt lgkmcnt(10)
    v_mfma_f32_16x16x32_bf16 v[56:59], v[156:159], v[192:195], v[56:59]
    v_mfma_f32_16x16x32_bf16 v[60:63], v[156:159], v[196:199], v[60:63]
    ds_read_b64_tr_b16 v[148:149], v201 offset:416
    ds_read_b64_tr_b16 v[150:151], v201 offset:14752
    s_waitcnt lgkmcnt(10)
    v_mfma_f32_16x16x32_bf16 v[64:67], v[128:131], v[192:195], v[64:67]
    v_mfma_f32_16x16x32_bf16 v[68:71], v[128:131], v[196:199], v[68:71]
    s_waitcnt lgkmcnt(8)
    v_mfma_f32_16x16x32_bf16 v[72:75], v[132:135], v[192:195], v[72:75]
    v_mfma_f32_16x16x32_bf16 v[76:79], v[132:135], v[196:199], v[76:79]
    s_waitcnt lgkmcnt(6)
    v_mfma_f32_16x16x32_bf16 v[80:83], v[136:139], v[192:195], v[80:83]
    v_mfma_f32_16x16x32_bf16 v[84:87], v[136:139], v[196:199], v[84:87]
    s_waitcnt lgkmcnt(4)
    v_mfma_f32_16x16x32_bf16 v[88:91], v[140:143], v[192:195], v[88:91]
    v_mfma_f32_16x16x32_bf16 v[92:95], v[140:143], v[196:199], v[92:95]
    s_waitcnt lgkmcnt(2)
    v_mfma_f32_16x16x32_bf16 v[96:99], v[144:147], v[192:195], v[96:99]
    v_mfma_f32_16x16x32_bf16 v[100:103], v[144:147], v[196:199], v[100:103]
    s_waitcnt lgkmcnt(0)
    v_mfma_f32_16x16x32_bf16 v[104:107], v[148:151], v[192:195], v[104:107]
    v_mfma_f32_16x16x32_bf16 v[108:111], v[148:151], v[196:199], v[108:111]
    v_add_u32 v200, 32768, v200
    v_add_u32 v201, 32768, v201
    v_add_u32 v202, 32768, v202
    v_add_u32 v203, 32768, v203
    s_lshr_b32 s60, s96, 3
    s_lshl_b32 s60, s60, 15
    s_and_b32 s61, s96, 7
    s_lshl_b32 s61, s61, 11
    s_add_u32 s60, s60, s61
    v_add_u32 v233, s60, v232
    s_add_u32 s96, s96, 1
    s_and_b32 s96, s96, 15
    s_barrier
    ds_read_b128 v[192:195], v233 offset:0
    ds_read_b128 v[196:199], v233 offset:1024
    ds_read_b64_tr_b16 v[128:129], v200 offset:0
    ds_read_b64_tr_b16 v[130:131], v200 offset:14336
    ds_read_b64_tr_b16 v[132:133], v201 offset:32
    ds_read_b64_tr_b16 v[134:135], v201 offset:14368
    ds_read_b64_tr_b16 v[136:137], v202 offset:64
    ds_read_b64_tr_b16 v[138:139], v202 offset:14400
    ds_read_b64_tr_b16 v[140:141], v203 offset:96
    ds_read_b64_tr_b16 v[142:143], v203 offset:14432
    ds_read_b64_tr_b16 v[144:145], v200 offset:128
    ds_read_b64_tr_b16 v[146:147], v200 offset:14464
    ds_read_b64_tr_b16 v[148:149], v201 offset:160
    ds_read_b64_tr_b16 v[150:151], v201 offset:14496
    s_waitcnt lgkmcnt(10)
    v_mfma_f32_16x16x32_bf16 v[0:3], v[128:131], v[192:195], v[0:3]
    v_mfma_f32_16x16x32_bf16 v[4:7], v[128:131], v[196:199], v[4:7]
    ds_read_b64_tr_b16 v[152:153], v202 offset:192
    ds_read_b64_tr_b16 v[154:155], v202 offset:14528
    s_waitcnt lgkmcnt(10)
    v_mfma_f32_16x16x32_bf16 v[8:11], v[132:135], v[192:195], v[8:11]
    v_mfma_f32_16x16x32_bf16 v[12:15], v[132:135], v[196:199], v[12:15]
    ds_read_b64_tr_b16 v[156:157], v203 offset:224
    ds_read_b64_tr_b16 v[158:159], v203 offset:14560
    s_waitcnt lgkmcnt(10)
    v_mfma_f32_16x16x32_bf16 v[16:19], v[136:139], v[192:195], v[16:19]
    v_mfma_f32_16x16x32_bf16 v[20:23], v[136:139], v[196:199], v[20:23]
    ds_read_b64_tr_b16 v[128:129], v200 offset:256
    ds_read_b64_tr_b16 v[130:131], v200 offset:14592
    s_waitcnt lgkmcnt(10)
    v_mfma_f32_16x16x32_bf16 v[24:27], v[140:143], v[192:195], v[24:27]
    v_mfma_f32_16x16x32_bf16 v[28:31], v[140:143], v[196:199], v[28:31]
    ds_read_b64_tr_b16 v[132:133], v201 offset:288
    ds_read_b64_tr_b16 v[134:135], v201 offset:14624
    s_waitcnt lgkmcnt(10)
    v_mfma_f32_16x16x32_bf16 v[32:35], v[144:147], v[192:195], v[32:35]
    v_mfma_f32_16x16x32_bf16 v[36:39], v[144:147], v[196:199], v[36:39]
    ds_read_b64_tr_b16 v[136:137], v202 offset:320
    ds_read_b64_tr_b16 v[138:139], v202 offset:14656
    s_waitcnt lgkmcnt(10)
    v_mfma_f32_16x16x32_bf16 v[40:43], v[148:151], v[192:195], v[40:43]
    v_mfma_f32_16x16x32_bf16 v[44:47], v[148:151], v[196:199], v[44:47]
    ds_read_b64_tr_b16 v[140:141], v203 offset:352
    ds_read_b64_tr_b16 v[142:143], v203 offset:14688
    s_waitcnt lgkmcnt(10)
    v_mfma_f32_16x16x32_bf16 v[48:51], v[152:155], v[192:195], v[48:51]
    v_mfma_f32_16x16x32_bf16 v[52:55], v[152:155], v[196:199], v[52:55]
    ds_read_b64_tr_b16 v[144:145], v200 offset:384
    ds_read_b64_tr_b16 v[146:147], v200 offset:14720
    s_waitcnt lgkmcnt(10)
    v_mfma_f32_16x16x32_bf16 v[56:59], v[156:159], v[192:195], v[56:59]
    v_mfma_f32_16x16x32_bf16 v[60:63], v[156:159], v[196:199], v[60:63]
    ds_read_b64_tr_b16 v[148:149], v201 offset:416
    ds_read_b64_tr_b16 v[150:151], v201 offset:14752
    s_waitcnt lgkmcnt(10)
    v_mfma_f32_16x16x32_bf16 v[64:67], v[128:131], v[192:195], v[64:67]
    v_mfma_f32_16x16x32_bf16 v[68:71], v[128:131], v[196:199], v[68:71]
    s_waitcnt lgkmcnt(8)
    v_mfma_f32_16x16x32_bf16 v[72:75], v[132:135], v[192:195], v[72:75]
    v_mfma_f32_16x16x32_bf16 v[76:79], v[132:135], v[196:199], v[76:79]
    s_waitcnt lgkmcnt(6)
    v_mfma_f32_16x16x32_bf16 v[80:83], v[136:139], v[192:195], v[80:83]
    v_mfma_f32_16x16x32_bf16 v[84:87], v[136:139], v[196:199], v[84:87]
    s_waitcnt lgkmcnt(4)
    v_mfma_f32_16x16x32_bf16 v[88:91], v[140:143], v[192:195], v[88:91]
    v_mfma_f32_16x16x32_bf16 v[92:95], v[140:143], v[196:199], v[92:95]
    s_waitcnt lgkmcnt(2)
    v_mfma_f32_16x16x32_bf16 v[96:99], v[144:147], v[192:195], v[96:99]
    v_mfma_f32_16x16x32_bf16 v[100:103], v[144:147], v[196:199], v[100:103]
    s_waitcnt lgkmcnt(0)
    v_mfma_f32_16x16x32_bf16 v[104:107], v[148:151], v[192:195], v[104:107]
    v_mfma_f32_16x16x32_bf16 v[108:111], v[148:151], v[196:199], v[108:111]
    v_add_u32 v200, 4294901760, v200
    v_add_u32 v201, 4294901760, v201
    v_add_u32 v202, 4294901760, v202
    v_add_u32 v203, 4294901760, v203
    s_lshr_b32 s60, s96, 3
    s_lshl_b32 s60, s60, 15
    s_and_b32 s61, s96, 7
    s_lshl_b32 s61, s61, 11
    s_add_u32 s60, s60, s61
    v_add_u32 v233, s60, v232
    s_add_u32 s96, s96, 1
    s_and_b32 s96, s96, 15
    s_barrier
    ds_read_b128 v[192:195], v233 offset:0
    ds_read_b128 v[196:199], v233 offset:1024
    ds_read_b64_tr_b16 v[128:129], v200 offset:0
    ds_read_b64_tr_b16 v[130:131], v200 offset:14336
    ds_read_b64_tr_b16 v[132:133], v201 offset:32
    ds_read_b64_tr_b16 v[134:135], v201 offset:14368
    ds_read_b64_tr_b16 v[136:137], v202 offset:64
    ds_read_b64_tr_b16 v[138:139], v202 offset:14400
    ds_read_b64_tr_b16 v[140:141], v203 offset:96
    ds_read_b64_tr_b16 v[142:143], v203 offset:14432
    ds_read_b64_tr_b16 v[144:145], v200 offset:128
    ds_read_b64_tr_b16 v[146:147], v200 offset:14464
    ds_read_b64_tr_b16 v[148:149], v201 offset:160
    ds_read_b64_tr_b16 v[150:151], v201 offset:14496
    s_waitcnt lgkmcnt(10)
    v_mfma_f32_16x16x32_bf16 v[0:3], v[128:131], v[192:195], v[0:3]
    v_mfma_f32_16x16x32_bf16 v[4:7], v[128:131], v[196:199], v[4:7]
    ds_read_b64_tr_b16 v[152:153], v202 offset:192
    ds_read_b64_tr_b16 v[154:155], v202 offset:14528
    s_waitcnt lgkmcnt(10)
    v_mfma_f32_16x16x32_bf16 v[8:11], v[132:135], v[192:195], v[8:11]
    v_mfma_f32_16x16x32_bf16 v[12:15], v[132:135], v[196:199], v[12:15]
    ds_read_b64_tr_b16 v[156:157], v203 offset:224
    ds_read_b64_tr_b16 v[158:159], v203 offset:14560
    s_waitcnt lgkmcnt(10)
    v_mfma_f32_16x16x32_bf16 v[16:19], v[136:139], v[192:195], v[16:19]
    v_mfma_f32_16x16x32_bf16 v[20:23], v[136:139], v[196:199], v[20:23]
    ds_read_b64_tr_b16 v[128:129], v200 offset:256
    ds_read_b64_tr_b16 v[130:131], v200 offset:14592
    s_waitcnt lgkmcnt(10)
    v_mfma_f32_16x16x32_bf16 v[24:27], v[140:143], v[192:195], v[24:27]
    v_mfma_f32_16x16x32_bf16 v[28:31], v[140:143], v[196:199], v[28:31]
    ds_read_b64_tr_b16 v[132:133], v201 offset:288
    ds_read_b64_tr_b16 v[134:135], v201 offset:14624
    s_waitcnt lgkmcnt(10)
    v_mfma_f32_16x16x32_bf16 v[32:35], v[144:147], v[192:195], v[32:35]
    v_mfma_f32_16x16x32_bf16 v[36:39], v[144:147], v[196:199], v[36:39]
    ds_read_b64_tr_b16 v[136:137], v202 offset:320
    ds_read_b64_tr_b16 v[138:139], v202 offset:14656
    s_waitcnt lgkmcnt(10)
    v_mfma_f32_16x16x32_bf16 v[40:43], v[148:151], v[192:195], v[40:43]
    v_mfma_f32_16x16x32_bf16 v[44:47], v[148:151], v[196:199], v[44:47]
    ds_read_b64_tr_b16 v[140:141], v203 offset:352
    ds_read_b64_tr_b16 v[142:143], v203 offset:14688
    s_waitcnt lgkmcnt(10)
    v_mfma_f32_16x16x32_bf16 v[48:51], v[152:155], v[192:195], v[48:51]
    v_mfma_f32_16x16x32_bf16 v[52:55], v[152:155], v[196:199], v[52:55]
    ds_read_b64_tr_b16 v[144:145], v200 offset:384
    ds_read_b64_tr_b16 v[146:147], v200 offset:14720
    s_waitcnt lgkmcnt(10)
    v_mfma_f32_16x16x32_bf16 v[56:59], v[156:159], v[192:195], v[56:59]
    v_mfma_f32_16x16x32_bf16 v[60:63], v[156:159], v[196:199], v[60:63]
    ds_read_b64_tr_b16 v[148:149], v201 offset:416
    ds_read_b64_tr_b16 v[150:151], v201 offset:14752
    s_waitcnt lgkmcnt(10)
    v_mfma_f32_16x16x32_bf16 v[64:67], v[128:131], v[192:195], v[64:67]
    v_mfma_f32_16x16x32_bf16 v[68:71], v[128:131], v[196:199], v[68:71]
    s_waitcnt lgkmcnt(8)
    v_mfma_f32_16x16x32_bf16 v[72:75], v[132:135], v[192:195], v[72:75]
    v_mfma_f32_16x16x32_bf16 v[76:79], v[132:135], v[196:199], v[76:79]
    s_waitcnt lgkmcnt(6)
    v_mfma_f32_16x16x32_bf16 v[80:83], v[136:139], v[192:195], v[80:83]
    v_mfma_f32_16x16x32_bf16 v[84:87], v[136:139], v[196:199], v[84:87]
    s_waitcnt lgkmcnt(4)
    v_mfma_f32_16x16x32_bf16 v[88:91], v[140:143], v[192:195], v[88:91]
    v_mfma_f32_16x16x32_bf16 v[92:95], v[140:143], v[196:199], v[92:95]
    s_waitcnt lgkmcnt(2)
    v_mfma_f32_16x16x32_bf16 v[96:99], v[144:147], v[192:195], v[96:99]
    v_mfma_f32_16x16x32_bf16 v[100:103], v[144:147], v[196:199], v[100:103]
    s_waitcnt lgkmcnt(0)
    v_mfma_f32_16x16x32_bf16 v[104:107], v[148:151], v[192:195], v[104:107]
    v_mfma_f32_16x16x32_bf16 v[108:111], v[148:151], v[196:199], v[108:111]
    v_add_u32 v200, 32768, v200
    v_add_u32 v201, 32768, v201
    v_add_u32 v202, 32768, v202
    v_add_u32 v203, 32768, v203
    s_lshr_b32 s60, s96, 3
    s_lshl_b32 s60, s60, 15
    s_and_b32 s61, s96, 7
    s_lshl_b32 s61, s61, 11
    s_add_u32 s60, s60, s61
    v_add_u32 v233, s60, v232
    s_add_u32 s96, s96, 1
    s_and_b32 s96, s96, 15
    s_barrier
    ds_read_b128 v[192:195], v233 offset:0
    ds_read_b128 v[196:199], v233 offset:1024
    ds_read_b64_tr_b16 v[128:129], v200 offset:0
    ds_read_b64_tr_b16 v[130:131], v200 offset:14336
    ds_read_b64_tr_b16 v[132:133], v201 offset:32
    ds_read_b64_tr_b16 v[134:135], v201 offset:14368
    ds_read_b64_tr_b16 v[136:137], v202 offset:64
    ds_read_b64_tr_b16 v[138:139], v202 offset:14400
    ds_read_b64_tr_b16 v[140:141], v203 offset:96
    ds_read_b64_tr_b16 v[142:143], v203 offset:14432
    ds_read_b64_tr_b16 v[144:145], v200 offset:128
    ds_read_b64_tr_b16 v[146:147], v200 offset:14464
    ds_read_b64_tr_b16 v[148:149], v201 offset:160
    ds_read_b64_tr_b16 v[150:151], v201 offset:14496
    s_waitcnt lgkmcnt(10)
    v_mfma_f32_16x16x32_bf16 v[0:3], v[128:131], v[192:195], v[0:3]
    v_mfma_f32_16x16x32_bf16 v[4:7], v[128:131], v[196:199], v[4:7]
    ds_read_b64_tr_b16 v[152:153], v202 offset:192
    ds_read_b64_tr_b16 v[154:155], v202 offset:14528
    s_waitcnt lgkmcnt(10)
    v_mfma_f32_16x16x32_bf16 v[8:11], v[132:135], v[192:195], v[8:11]
    v_mfma_f32_16x16x32_bf16 v[12:15], v[132:135], v[196:199], v[12:15]
    ds_read_b64_tr_b16 v[156:157], v203 offset:224
    ds_read_b64_tr_b16 v[158:159], v203 offset:14560
    s_waitcnt lgkmcnt(10)
    v_mfma_f32_16x16x32_bf16 v[16:19], v[136:139], v[192:195], v[16:19]
    v_mfma_f32_16x16x32_bf16 v[20:23], v[136:139], v[196:199], v[20:23]
    ds_read_b64_tr_b16 v[128:129], v200 offset:256
    ds_read_b64_tr_b16 v[130:131], v200 offset:14592
    s_waitcnt lgkmcnt(10)
    v_mfma_f32_16x16x32_bf16 v[24:27], v[140:143], v[192:195], v[24:27]
    v_mfma_f32_16x16x32_bf16 v[28:31], v[140:143], v[196:199], v[28:31]
    ds_read_b64_tr_b16 v[132:133], v201 offset:288
    ds_read_b64_tr_b16 v[134:135], v201 offset:14624
    s_waitcnt lgkmcnt(10)
    v_mfma_f32_16x16x32_bf16 v[32:35], v[144:147], v[192:195], v[32:35]
    v_mfma_f32_16x16x32_bf16 v[36:39], v[144:147], v[196:199], v[36:39]
    ds_read_b64_tr_b16 v[136:137], v202 offset:320
    ds_read_b64_tr_b16 v[138:139], v202 offset:14656
    s_waitcnt lgkmcnt(10)
    v_mfma_f32_16x16x32_bf16 v[40:43], v[148:151], v[192:195], v[40:43]
    v_mfma_f32_16x16x32_bf16 v[44:47], v[148:151], v[196:199], v[44:47]
    ds_read_b64_tr_b16 v[140:141], v203 offset:352
    ds_read_b64_tr_b16 v[142:143], v203 offset:14688
    s_waitcnt lgkmcnt(10)
    v_mfma_f32_16x16x32_bf16 v[48:51], v[152:155], v[192:195], v[48:51]
    v_mfma_f32_16x16x32_bf16 v[52:55], v[152:155], v[196:199], v[52:55]
    ds_read_b64_tr_b16 v[144:145], v200 offset:384
    ds_read_b64_tr_b16 v[146:147], v200 offset:14720
    s_waitcnt lgkmcnt(10)
    v_mfma_f32_16x16x32_bf16 v[56:59], v[156:159], v[192:195], v[56:59]
    v_mfma_f32_16x16x32_bf16 v[60:63], v[156:159], v[196:199], v[60:63]
    ds_read_b64_tr_b16 v[148:149], v201 offset:416
    ds_read_b64_tr_b16 v[150:151], v201 offset:14752
    s_waitcnt lgkmcnt(10)
    v_mfma_f32_16x16x32_bf16 v[64:67], v[128:131], v[192:195], v[64:67]
    v_mfma_f32_16x16x32_bf16 v[68:71], v[128:131], v[196:199], v[68:71]
    s_waitcnt lgkmcnt(8)
    v_mfma_f32_16x16x32_bf16 v[72:75], v[132:135], v[192:195], v[72:75]
    v_mfma_f32_16x16x32_bf16 v[76:79], v[132:135], v[196:199], v[76:79]
    s_waitcnt lgkmcnt(6)
    v_mfma_f32_16x16x32_bf16 v[80:83], v[136:139], v[192:195], v[80:83]
    v_mfma_f32_16x16x32_bf16 v[84:87], v[136:139], v[196:199], v[84:87]
    s_waitcnt lgkmcnt(4)
    v_mfma_f32_16x16x32_bf16 v[88:91], v[140:143], v[192:195], v[88:91]
    v_mfma_f32_16x16x32_bf16 v[92:95], v[140:143], v[196:199], v[92:95]
    s_waitcnt lgkmcnt(2)
    v_mfma_f32_16x16x32_bf16 v[96:99], v[144:147], v[192:195], v[96:99]
    v_mfma_f32_16x16x32_bf16 v[100:103], v[144:147], v[196:199], v[100:103]
    s_waitcnt lgkmcnt(0)
    v_mfma_f32_16x16x32_bf16 v[104:107], v[148:151], v[192:195], v[104:107]
    v_mfma_f32_16x16x32_bf16 v[108:111], v[148:151], v[196:199], v[108:111]
    v_add_u32 v200, 32768, v200
    v_add_u32 v201, 32768, v201
    v_add_u32 v202, 32768, v202
    v_add_u32 v203, 32768, v203
    s_lshr_b32 s60, s96, 3
    s_lshl_b32 s60, s60, 15
    s_and_b32 s61, s96, 7
    s_lshl_b32 s61, s61, 11
    s_add_u32 s60, s60, s61
    v_add_u32 v233, s60, v232
    s_add_u32 s96, s96, 1
    s_and_b32 s96, s96, 15
    s_barrier
    ds_read_b128 v[192:195], v233 offset:0
    ds_read_b128 v[196:199], v233 offset:1024
    ds_read_b64_tr_b16 v[128:129], v200 offset:0
    ds_read_b64_tr_b16 v[130:131], v200 offset:14336
    ds_read_b64_tr_b16 v[132:133], v201 offset:32
    ds_read_b64_tr_b16 v[134:135], v201 offset:14368
    ds_read_b64_tr_b16 v[136:137], v202 offset:64
    ds_read_b64_tr_b16 v[138:139], v202 offset:14400
    ds_read_b64_tr_b16 v[140:141], v203 offset:96
    ds_read_b64_tr_b16 v[142:143], v203 offset:14432
    ds_read_b64_tr_b16 v[144:145], v200 offset:128
    ds_read_b64_tr_b16 v[146:147], v200 offset:14464
    ds_read_b64_tr_b16 v[148:149], v201 offset:160
    ds_read_b64_tr_b16 v[150:151], v201 offset:14496
    s_waitcnt lgkmcnt(10)
    v_mfma_f32_16x16x32_bf16 v[0:3], v[128:131], v[192:195], v[0:3]
    v_mfma_f32_16x16x32_bf16 v[4:7], v[128:131], v[196:199], v[4:7]
    ds_read_b64_tr_b16 v[152:153], v202 offset:192
    ds_read_b64_tr_b16 v[154:155], v202 offset:14528
    s_waitcnt lgkmcnt(10)
    v_mfma_f32_16x16x32_bf16 v[8:11], v[132:135], v[192:195], v[8:11]
    v_mfma_f32_16x16x32_bf16 v[12:15], v[132:135], v[196:199], v[12:15]
    ds_read_b64_tr_b16 v[156:157], v203 offset:224
    ds_read_b64_tr_b16 v[158:159], v203 offset:14560
    s_waitcnt lgkmcnt(10)
    v_mfma_f32_16x16x32_bf16 v[16:19], v[136:139], v[192:195], v[16:19]
    v_mfma_f32_16x16x32_bf16 v[20:23], v[136:139], v[196:199], v[20:23]
    ds_read_b64_tr_b16 v[128:129], v200 offset:256
    ds_read_b64_tr_b16 v[130:131], v200 offset:14592
    s_waitcnt lgkmcnt(10)
    v_mfma_f32_16x16x32_bf16 v[24:27], v[140:143], v[192:195], v[24:27]
    v_mfma_f32_16x16x32_bf16 v[28:31], v[140:143], v[196:199], v[28:31]
    ds_read_b64_tr_b16 v[132:133], v201 offset:288
    ds_read_b64_tr_b16 v[134:135], v201 offset:14624
    s_waitcnt lgkmcnt(10)
    v_mfma_f32_16x16x32_bf16 v[32:35], v[144:147], v[192:195], v[32:35]
    v_mfma_f32_16x16x32_bf16 v[36:39], v[144:147], v[196:199], v[36:39]
    ds_read_b64_tr_b16 v[136:137], v202 offset:320
    ds_read_b64_tr_b16 v[138:139], v202 offset:14656
    s_waitcnt lgkmcnt(10)
    v_mfma_f32_16x16x32_bf16 v[40:43], v[148:151], v[192:195], v[40:43]
    v_mfma_f32_16x16x32_bf16 v[44:47], v[148:151], v[196:199], v[44:47]
    ds_read_b64_tr_b16 v[140:141], v203 offset:352
    ds_read_b64_tr_b16 v[142:143], v203 offset:14688
    s_waitcnt lgkmcnt(10)
    v_mfma_f32_16x16x32_bf16 v[48:51], v[152:155], v[192:195], v[48:51]
    v_mfma_f32_16x16x32_bf16 v[52:55], v[152:155], v[196:199], v[52:55]
    ds_read_b64_tr_b16 v[144:145], v200 offset:384
    ds_read_b64_tr_b16 v[146:147], v200 offset:14720
    s_waitcnt lgkmcnt(10)
    v_mfma_f32_16x16x32_bf16 v[56:59], v[156:159], v[192:195], v[56:59]
    v_mfma_f32_16x16x32_bf16 v[60:63], v[156:159], v[196:199], v[60:63]
    ds_read_b64_tr_b16 v[148:149], v201 offset:416
    ds_read_b64_tr_b16 v[150:151], v201 offset:14752
    s_waitcnt lgkmcnt(10)
    v_mfma_f32_16x16x32_bf16 v[64:67], v[128:131], v[192:195], v[64:67]
    v_mfma_f32_16x16x32_bf16 v[68:71], v[128:131], v[196:199], v[68:71]
    s_waitcnt lgkmcnt(8)
    v_mfma_f32_16x16x32_bf16 v[72:75], v[132:135], v[192:195], v[72:75]
    v_mfma_f32_16x16x32_bf16 v[76:79], v[132:135], v[196:199], v[76:79]
    s_waitcnt lgkmcnt(6)
    v_mfma_f32_16x16x32_bf16 v[80:83], v[136:139], v[192:195], v[80:83]
    v_mfma_f32_16x16x32_bf16 v[84:87], v[136:139], v[196:199], v[84:87]
    s_waitcnt lgkmcnt(4)
    v_mfma_f32_16x16x32_bf16 v[88:91], v[140:143], v[192:195], v[88:91]
    v_mfma_f32_16x16x32_bf16 v[92:95], v[140:143], v[196:199], v[92:95]
    s_waitcnt lgkmcnt(2)
    v_mfma_f32_16x16x32_bf16 v[96:99], v[144:147], v[192:195], v[96:99]
    v_mfma_f32_16x16x32_bf16 v[100:103], v[144:147], v[196:199], v[100:103]
    s_waitcnt lgkmcnt(0)
    v_mfma_f32_16x16x32_bf16 v[104:107], v[148:151], v[192:195], v[104:107]
    v_mfma_f32_16x16x32_bf16 v[108:111], v[148:151], v[196:199], v[108:111]
    v_add_u32 v200, 4294901760, v200
    v_add_u32 v201, 4294901760, v201
    v_add_u32 v202, 4294901760, v202
    v_add_u32 v203, 4294901760, v203
    s_lshr_b32 s60, s96, 3
    s_lshl_b32 s60, s60, 15
    s_and_b32 s61, s96, 7
    s_lshl_b32 s61, s61, 11
    s_add_u32 s60, s60, s61
    v_add_u32 v233, s60, v232
    s_add_u32 s96, s96, 1
    s_and_b32 s96, s96, 15
    s_barrier
    ds_read_b128 v[192:195], v233 offset:0
    ds_read_b128 v[196:199], v233 offset:1024
    ds_read_b64_tr_b16 v[128:129], v200 offset:0
    ds_read_b64_tr_b16 v[130:131], v200 offset:14336
    ds_read_b64_tr_b16 v[132:133], v201 offset:32
    ds_read_b64_tr_b16 v[134:135], v201 offset:14368
    ds_read_b64_tr_b16 v[136:137], v202 offset:64
    ds_read_b64_tr_b16 v[138:139], v202 offset:14400
    ds_read_b64_tr_b16 v[140:141], v203 offset:96
    ds_read_b64_tr_b16 v[142:143], v203 offset:14432
    ds_read_b64_tr_b16 v[144:145], v200 offset:128
    ds_read_b64_tr_b16 v[146:147], v200 offset:14464
    ds_read_b64_tr_b16 v[148:149], v201 offset:160
    ds_read_b64_tr_b16 v[150:151], v201 offset:14496
    s_waitcnt lgkmcnt(10)
    v_mfma_f32_16x16x32_bf16 v[0:3], v[128:131], v[192:195], v[0:3]
    v_mfma_f32_16x16x32_bf16 v[4:7], v[128:131], v[196:199], v[4:7]
    ds_read_b64_tr_b16 v[152:153], v202 offset:192
    ds_read_b64_tr_b16 v[154:155], v202 offset:14528
    s_waitcnt lgkmcnt(10)
    v_mfma_f32_16x16x32_bf16 v[8:11], v[132:135], v[192:195], v[8:11]
    v_mfma_f32_16x16x32_bf16 v[12:15], v[132:135], v[196:199], v[12:15]
    ds_read_b64_tr_b16 v[156:157], v203 offset:224
    ds_read_b64_tr_b16 v[158:159], v203 offset:14560
    s_waitcnt lgkmcnt(10)
    v_mfma_f32_16x16x32_bf16 v[16:19], v[136:139], v[192:195], v[16:19]
    v_mfma_f32_16x16x32_bf16 v[20:23], v[136:139], v[196:199], v[20:23]
    ds_read_b64_tr_b16 v[128:129], v200 offset:256
    ds_read_b64_tr_b16 v[130:131], v200 offset:14592
    s_waitcnt lgkmcnt(10)
    v_mfma_f32_16x16x32_bf16 v[24:27], v[140:143], v[192:195], v[24:27]
    v_mfma_f32_16x16x32_bf16 v[28:31], v[140:143], v[196:199], v[28:31]
    ds_read_b64_tr_b16 v[132:133], v201 offset:288
    ds_read_b64_tr_b16 v[134:135], v201 offset:14624
    s_waitcnt lgkmcnt(10)
    v_mfma_f32_16x16x32_bf16 v[32:35], v[144:147], v[192:195], v[32:35]
    v_mfma_f32_16x16x32_bf16 v[36:39], v[144:147], v[196:199], v[36:39]
    ds_read_b64_tr_b16 v[136:137], v202 offset:320
    ds_read_b64_tr_b16 v[138:139], v202 offset:14656
    s_waitcnt lgkmcnt(10)
    v_mfma_f32_16x16x32_bf16 v[40:43], v[148:151], v[192:195], v[40:43]
    v_mfma_f32_16x16x32_bf16 v[44:47], v[148:151], v[196:199], v[44:47]
    ds_read_b64_tr_b16 v[140:141], v203 offset:352
    ds_read_b64_tr_b16 v[142:143], v203 offset:14688
    s_waitcnt lgkmcnt(10)
    v_mfma_f32_16x16x32_bf16 v[48:51], v[152:155], v[192:195], v[48:51]
    v_mfma_f32_16x16x32_bf16 v[52:55], v[152:155], v[196:199], v[52:55]
    ds_read_b64_tr_b16 v[144:145], v200 offset:384
    ds_read_b64_tr_b16 v[146:147], v200 offset:14720
    s_waitcnt lgkmcnt(10)
    v_mfma_f32_16x16x32_bf16 v[56:59], v[156:159], v[192:195], v[56:59]
    v_mfma_f32_16x16x32_bf16 v[60:63], v[156:159], v[196:199], v[60:63]
    ds_read_b64_tr_b16 v[148:149], v201 offset:416
    ds_read_b64_tr_b16 v[150:151], v201 offset:14752
    s_waitcnt lgkmcnt(10)
    v_mfma_f32_16x16x32_bf16 v[64:67], v[128:131], v[192:195], v[64:67]
    v_mfma_f32_16x16x32_bf16 v[68:71], v[128:131], v[196:199], v[68:71]
    s_waitcnt lgkmcnt(8)
    v_mfma_f32_16x16x32_bf16 v[72:75], v[132:135], v[192:195], v[72:75]
    v_mfma_f32_16x16x32_bf16 v[76:79], v[132:135], v[196:199], v[76:79]
    s_waitcnt lgkmcnt(6)
    v_mfma_f32_16x16x32_bf16 v[80:83], v[136:139], v[192:195], v[80:83]
    v_mfma_f32_16x16x32_bf16 v[84:87], v[136:139], v[196:199], v[84:87]
    s_waitcnt lgkmcnt(4)
    v_mfma_f32_16x16x32_bf16 v[88:91], v[140:143], v[192:195], v[88:91]
    v_mfma_f32_16x16x32_bf16 v[92:95], v[140:143], v[196:199], v[92:95]
    s_waitcnt lgkmcnt(2)
    v_mfma_f32_16x16x32_bf16 v[96:99], v[144:147], v[192:195], v[96:99]
    v_mfma_f32_16x16x32_bf16 v[100:103], v[144:147], v[196:199], v[100:103]
    s_waitcnt lgkmcnt(0)
    v_mfma_f32_16x16x32_bf16 v[104:107], v[148:151], v[192:195], v[104:107]
    v_mfma_f32_16x16x32_bf16 v[108:111], v[148:151], v[196:199], v[108:111]
    v_add_u32 v200, 32768, v200
    v_add_u32 v201, 32768, v201
    v_add_u32 v202, 32768, v202
    v_add_u32 v203, 32768, v203
    s_lshr_b32 s60, s96, 3
    s_lshl_b32 s60, s60, 15
    s_and_b32 s61, s96, 7
    s_lshl_b32 s61, s61, 11
    s_add_u32 s60, s60, s61
    v_add_u32 v233, s60, v232
    s_add_u32 s96, s96, 1
    s_and_b32 s96, s96, 15
    s_barrier
    ds_read_b128 v[192:195], v233 offset:0
    ds_read_b128 v[196:199], v233 offset:1024
    ds_read_b64_tr_b16 v[128:129], v200 offset:0
    ds_read_b64_tr_b16 v[130:131], v200 offset:14336
    ds_read_b64_tr_b16 v[132:133], v201 offset:32
    ds_read_b64_tr_b16 v[134:135], v201 offset:14368
    ds_read_b64_tr_b16 v[136:137], v202 offset:64
    ds_read_b64_tr_b16 v[138:139], v202 offset:14400
    ds_read_b64_tr_b16 v[140:141], v203 offset:96
    ds_read_b64_tr_b16 v[142:143], v203 offset:14432
    ds_read_b64_tr_b16 v[144:145], v200 offset:128
    ds_read_b64_tr_b16 v[146:147], v200 offset:14464
    ds_read_b64_tr_b16 v[148:149], v201 offset:160
    ds_read_b64_tr_b16 v[150:151], v201 offset:14496
    s_waitcnt lgkmcnt(10)
    v_mfma_f32_16x16x32_bf16 v[0:3], v[128:131], v[192:195], v[0:3]
    v_mfma_f32_16x16x32_bf16 v[4:7], v[128:131], v[196:199], v[4:7]
    ds_read_b64_tr_b16 v[152:153], v202 offset:192
    ds_read_b64_tr_b16 v[154:155], v202 offset:14528
    s_waitcnt lgkmcnt(10)
    v_mfma_f32_16x16x32_bf16 v[8:11], v[132:135], v[192:195], v[8:11]
    v_mfma_f32_16x16x32_bf16 v[12:15], v[132:135], v[196:199], v[12:15]
    ds_read_b64_tr_b16 v[156:157], v203 offset:224
    ds_read_b64_tr_b16 v[158:159], v203 offset:14560
    s_waitcnt lgkmcnt(10)
    v_mfma_f32_16x16x32_bf16 v[16:19], v[136:139], v[192:195], v[16:19]
    v_mfma_f32_16x16x32_bf16 v[20:23], v[136:139], v[196:199], v[20:23]
    ds_read_b64_tr_b16 v[128:129], v200 offset:256
    ds_read_b64_tr_b16 v[130:131], v200 offset:14592
    s_waitcnt lgkmcnt(10)
    v_mfma_f32_16x16x32_bf16 v[24:27], v[140:143], v[192:195], v[24:27]
    v_mfma_f32_16x16x32_bf16 v[28:31], v[140:143], v[196:199], v[28:31]
    ds_read_b64_tr_b16 v[132:133], v201 offset:288
    ds_read_b64_tr_b16 v[134:135], v201 offset:14624
    s_waitcnt lgkmcnt(10)
    v_mfma_f32_16x16x32_bf16 v[32:35], v[144:147], v[192:195], v[32:35]
    v_mfma_f32_16x16x32_bf16 v[36:39], v[144:147], v[196:199], v[36:39]
    ds_read_b64_tr_b16 v[136:137], v202 offset:320
    ds_read_b64_tr_b16 v[138:139], v202 offset:14656
    s_waitcnt lgkmcnt(10)
    v_mfma_f32_16x16x32_bf16 v[40:43], v[148:151], v[192:195], v[40:43]
    v_mfma_f32_16x16x32_bf16 v[44:47], v[148:151], v[196:199], v[44:47]
    ds_read_b64_tr_b16 v[140:141], v203 offset:352
    ds_read_b64_tr_b16 v[142:143], v203 offset:14688
    s_waitcnt lgkmcnt(10)
    v_mfma_f32_16x16x32_bf16 v[48:51], v[152:155], v[192:195], v[48:51]
    v_mfma_f32_16x16x32_bf16 v[52:55], v[152:155], v[196:199], v[52:55]
    ds_read_b64_tr_b16 v[144:145], v200 offset:384
    ds_read_b64_tr_b16 v[146:147], v200 offset:14720
    s_waitcnt lgkmcnt(10)
    v_mfma_f32_16x16x32_bf16 v[56:59], v[156:159], v[192:195], v[56:59]
    v_mfma_f32_16x16x32_bf16 v[60:63], v[156:159], v[196:199], v[60:63]
    ds_read_b64_tr_b16 v[148:149], v201 offset:416
    ds_read_b64_tr_b16 v[150:151], v201 offset:14752
    s_waitcnt lgkmcnt(10)
    v_mfma_f32_16x16x32_bf16 v[64:67], v[128:131], v[192:195], v[64:67]
    v_mfma_f32_16x16x32_bf16 v[68:71], v[128:131], v[196:199], v[68:71]
    s_waitcnt lgkmcnt(8)
    v_mfma_f32_16x16x32_bf16 v[72:75], v[132:135], v[192:195], v[72:75]
    v_mfma_f32_16x16x32_bf16 v[76:79], v[132:135], v[196:199], v[76:79]
    s_waitcnt lgkmcnt(6)
    v_mfma_f32_16x16x32_bf16 v[80:83], v[136:139], v[192:195], v[80:83]
    v_mfma_f32_16x16x32_bf16 v[84:87], v[136:139], v[196:199], v[84:87]
    s_waitcnt lgkmcnt(4)
    v_mfma_f32_16x16x32_bf16 v[88:91], v[140:143], v[192:195], v[88:91]
    v_mfma_f32_16x16x32_bf16 v[92:95], v[140:143], v[196:199], v[92:95]
    s_waitcnt lgkmcnt(2)
    v_mfma_f32_16x16x32_bf16 v[96:99], v[144:147], v[192:195], v[96:99]
    v_mfma_f32_16x16x32_bf16 v[100:103], v[144:147], v[196:199], v[100:103]
    s_waitcnt lgkmcnt(0)
    v_mfma_f32_16x16x32_bf16 v[104:107], v[148:151], v[192:195], v[104:107]
    v_mfma_f32_16x16x32_bf16 v[108:111], v[148:151], v[196:199], v[108:111]
    v_lshlrev_b32 v242, 4, v254
    s_mul_i32 s52, s37, 14336
    s_nop 15
    v_cvt_pk_bf16_f32 v128, v0, v1
    v_cvt_pk_bf16_f32 v129, v2, v3
    v_cvt_pk_bf16_f32 v130, v8, v9
    v_cvt_pk_bf16_f32 v131, v10, v11
    buffer_store_dwordx4 v[128:131], v242, s[48:51], s52 offen offset:0 sc0 sc1
    v_cvt_pk_bf16_f32 v132, v4, v5
    v_cvt_pk_bf16_f32 v133, v6, v7
    v_cvt_pk_bf16_f32 v134, v12, v13
    v_cvt_pk_bf16_f32 v135, v14, v15
    buffer_store_dwordx4 v[132:135], v242, s[48:51], s52 offen offset:1024 sc0 sc1
    v_cvt_pk_bf16_f32 v136, v16, v17
    v_cvt_pk_bf16_f32 v137, v18, v19
    v_cvt_pk_bf16_f32 v138, v24, v25
    v_cvt_pk_bf16_f32 v139, v26, v27
    buffer_store_dwordx4 v[136:139], v242, s[48:51], s52 offen offset:2048 sc0 sc1
    v_cvt_pk_bf16_f32 v140, v20, v21
    v_cvt_pk_bf16_f32 v141, v22, v23
    v_cvt_pk_bf16_f32 v142, v28, v29
    v_cvt_pk_bf16_f32 v143, v30, v31
    buffer_store_dwordx4 v[140:143], v242, s[48:51], s52 offen offset:3072 sc0 sc1
    s_add_u32 s52, s52, 4096
    v_cvt_pk_bf16_f32 v144, v32, v33
    v_cvt_pk_bf16_f32 v145, v34, v35
    v_cvt_pk_bf16_f32 v146, v40, v41
    v_cvt_pk_bf16_f32 v147, v42, v43
    buffer_store_dwordx4 v[144:147], v242, s[48:51], s52 offen offset:0 sc0 sc1
    v_cvt_pk_bf16_f32 v148, v36, v37
    v_cvt_pk_bf16_f32 v149, v38, v39
    v_cvt_pk_bf16_f32 v150, v44, v45
    v_cvt_pk_bf16_f32 v151, v46, v47
    buffer_store_dwordx4 v[148:151], v242, s[48:51], s52 offen offset:1024 sc0 sc1
    v_cvt_pk_bf16_f32 v152, v48, v49
    v_cvt_pk_bf16_f32 v153, v50, v51
    v_cvt_pk_bf16_f32 v154, v56, v57
    v_cvt_pk_bf16_f32 v155, v58, v59
    buffer_store_dwordx4 v[152:155], v242, s[48:51], s52 offen offset:2048 sc0 sc1
    v_cvt_pk_bf16_f32 v156, v52, v53
    v_cvt_pk_bf16_f32 v157, v54, v55
    v_cvt_pk_bf16_f32 v158, v60, v61
    v_cvt_pk_bf16_f32 v159, v62, v63
    buffer_store_dwordx4 v[156:159], v242, s[48:51], s52 offen offset:3072 sc0 sc1
    s_add_u32 s52, s52, 4096
    v_cvt_pk_bf16_f32 v160, v64, v65
    v_cvt_pk_bf16_f32 v161, v66, v67
    v_cvt_pk_bf16_f32 v162, v72, v73
    v_cvt_pk_bf16_f32 v163, v74, v75
    buffer_store_dwordx4 v[160:163], v242, s[48:51], s52 offen offset:0 sc0 sc1
    v_cvt_pk_bf16_f32 v164, v68, v69
    v_cvt_pk_bf16_f32 v165, v70, v71
    v_cvt_pk_bf16_f32 v166, v76, v77
    v_cvt_pk_bf16_f32 v167, v78, v79
    buffer_store_dwordx4 v[164:167], v242, s[48:51], s52 offen offset:1024 sc0 sc1
    v_cvt_pk_bf16_f32 v168, v80, v81
    v_cvt_pk_bf16_f32 v169, v82, v83
    v_cvt_pk_bf16_f32 v170, v88, v89
    v_cvt_pk_bf16_f32 v171, v90, v91
    buffer_store_dwordx4 v[168:171], v242, s[48:51], s52 offen offset:2048 sc0 sc1
    v_cvt_pk_bf16_f32 v172, v84, v85
    v_cvt_pk_bf16_f32 v173, v86, v87
    v_cvt_pk_bf16_f32 v174, v92, v93
    v_cvt_pk_bf16_f32 v175, v94, v95
    buffer_store_dwordx4 v[172:175], v242, s[48:51], s52 offen offset:3072 sc0 sc1
    s_add_u32 s52, s52, 4096
    v_cvt_pk_bf16_f32 v176, v96, v97
    v_cvt_pk_bf16_f32 v177, v98, v99
    v_cvt_pk_bf16_f32 v178, v104, v105
    v_cvt_pk_bf16_f32 v179, v106, v107
    buffer_store_dwordx4 v[176:179], v242, s[48:51], s52 offen offset:0 sc0 sc1
    v_cvt_pk_bf16_f32 v180, v100, v101
    v_cvt_pk_bf16_f32 v181, v102, v103
    v_cvt_pk_bf16_f32 v182, v108, v109
    v_cvt_pk_bf16_f32 v183, v110, v111
    buffer_store_dwordx4 v[180:183], v242, s[48:51], s52 offen offset:1024 sc0 sc1
    s_endpgm
L_rescale:
    s_nop 7
    v_max_f32 v242, v240, v236
    v_sub_f32 v243, v236, v242
    v_exp_f32 v243, v243
    v_mov_b32 v236, v242
    s_nop 0
    v_mul_f32 v238, v238, v243
    v_mul_f32 v0, v0, v243
    v_mul_f32 v1, v1, v243
    v_mul_f32 v2, v2, v243
    v_mul_f32 v3, v3, v243
    v_mul_f32 v8, v8, v243
    v_mul_f32 v9, v9, v243
    v_mul_f32 v10, v10, v243
    v_mul_f32 v11, v11, v243
    v_mul_f32 v16, v16, v243
    v_mul_f32 v17, v17, v243
    v_mul_f32 v18, v18, v243
    v_mul_f32 v19, v19, v243
    v_mul_f32 v24, v24, v243
    v_mul_f32 v25, v25, v243
    v_mul_f32 v26, v26, v243
    v_mul_f32 v27, v27, v243
    v_mul_f32 v32, v32, v243
    v_mul_f32 v33, v33, v243
    v_mul_f32 v34, v34, v243
    v_mul_f32 v35, v35, v243
    v_mul_f32 v40, v40, v243
    v_mul_f32 v41, v41, v243
    v_mul_f32 v42, v42, v243
    v_mul_f32 v43, v43, v243
    v_mul_f32 v48, v48, v243
    v_mul_f32 v49, v49, v243
    v_mul_f32 v50, v50, v243
    v_mul_f32 v51, v51, v243
    v_mul_f32 v56, v56, v243
    v_mul_f32 v57, v57, v243
    v_mul_f32 v58, v58, v243
    v_mul_f32 v59, v59, v243
    v_mul_f32 v64, v64, v243
    v_mul_f32 v65, v65, v243
    v_mul_f32 v66, v66, v243
    v_mul_f32 v67, v67, v243
    v_mul_f32 v72, v72, v243
    v_mul_f32 v73, v73, v243
    v_mul_f32 v74, v74, v243
    v_mul_f32 v75, v75, v243
    v_mul_f32 v80, v80, v243
    v_mul_f32 v81, v81, v243
    v_mul_f32 v82, v82, v243
    v_mul_f32 v83, v83, v243
    v_mul_f32 v88, v88, v243
    v_mul_f32 v89, v89, v243
    v_mul_f32 v90, v90, v243
    v_mul_f32 v91, v91, v243
    v_mul_f32 v96, v96, v243
    v_mul_f32 v97, v97, v243
    v_mul_f32 v98, v98, v243
    v_mul_f32 v99, v99, v243
    v_mul_f32 v104, v104, v243
    v_mul_f32 v105, v105, v243
    v_mul_f32 v106, v106, v243
    v_mul_f32 v107, v107, v243
    v_mul_f32 v112, v112, v243
    v_mul_f32 v113, v113, v243
    v_mul_f32 v114, v114, v243
    v_mul_f32 v115, v115, v243
    v_mul_f32 v120, v120, v243
    v_mul_f32 v121, v121, v243
    v_mul_f32 v122, v122, v243
    v_mul_f32 v123, v123, v243
    v_max_f32 v242, v241, v237
    v_sub_f32 v243, v237, v242
    v_exp_f32 v243, v243
    v_mov_b32 v237, v242
    s_nop 0
    v_mul_f32 v239, v239, v243
    v_mul_f32 v4, v4, v243
    v_mul_f32 v5, v5, v243
    v_mul_f32 v6, v6, v243
    v_mul_f32 v7, v7, v243
    v_mul_f32 v12, v12, v243
    v_mul_f32 v13, v13, v243
    v_mul_f32 v14, v14, v243
    v_mul_f32 v15, v15, v243
    v_mul_f32 v20, v20, v243
    v_mul_f32 v21, v21, v243
    v_mul_f32 v22, v22, v243
    v_mul_f32 v23, v23, v243
    v_mul_f32 v28, v28, v243
    v_mul_f32 v29, v29, v243
    v_mul_f32 v30, v30, v243
    v_mul_f32 v31, v31, v243
    v_mul_f32 v36, v36, v243
    v_mul_f32 v37, v37, v243
    v_mul_f32 v38, v38, v243
    v_mul_f32 v39, v39, v243
    v_mul_f32 v44, v44, v243
    v_mul_f32 v45, v45, v243
    v_mul_f32 v46, v46, v243
    v_mul_f32 v47, v47, v243
    v_mul_f32 v52, v52, v243
    v_mul_f32 v53, v53, v243
    v_mul_f32 v54, v54, v243
    v_mul_f32 v55, v55, v243
    v_mul_f32 v60, v60, v243
    v_mul_f32 v61, v61, v243
    v_mul_f32 v62, v62, v243
    v_mul_f32 v63, v63, v243
    v_mul_f32 v68, v68, v243
    v_mul_f32 v69, v69, v243
    v_mul_f32 v70, v70, v243
    v_mul_f32 v71, v71, v243
    v_mul_f32 v76, v76, v243
    v_mul_f32 v77, v77, v243
    v_mul_f32 v78, v78, v243
    v_mul_f32 v79, v79, v243
    v_mul_f32 v84, v84, v243
    v_mul_f32 v85, v85, v243
    v_mul_f32 v86, v86, v243
    v_mul_f32 v87, v87, v243
    v_mul_f32 v92, v92, v243
    v_mul_f32 v93, v93, v243
    v_mul_f32 v94, v94, v243
    v_mul_f32 v95, v95, v243
    v_mul_f32 v100, v100, v243
    v_mul_f32 v101, v101, v243
    v_mul_f32 v102, v102, v243
    v_mul_f32 v103, v103, v243
    v_mul_f32 v108, v108, v243
    v_mul_f32 v109, v109, v243
    v_mul_f32 v110, v110, v243
    v_mul_f32 v111, v111, v243
    v_mul_f32 v116, v116, v243
    v_mul_f32 v117, v117, v243
    v_mul_f32 v118, v118, v243
    v_mul_f32 v119, v119, v243
    v_mul_f32 v124, v124, v243
    v_mul_f32 v125, v125, v243
    v_mul_f32 v126, v126, v243
    v_mul_f32 v127, v127, v243
    s_branch L_rescale_done
L_producer:
    s_sub_u32 s58, s37, 4
    s_lshl_b32 s60, s35, 10
    s_add_u32 s12, s70, s60
    s_addc_u32 s13, s71, 0
    s_sub_u32 s14, 3670016, s60
    s_mov_b32 s15, 0x00020000
    v_lshrrev_b32 v2, 3, v254
    v_bfe_u32 v3, v254, 4, 1
    v_lshlrev_b32 v3, 2, v3
    v_and_b32 v4, 7, v254
    v_xor_b32 v4, v4, v3
    v_lshlrev_b32 v4, 4, v4
    v_lshlrev_b32 v2, 13, v2
    v_add_u32 v2, v2, v4
    s_lshl_b32 s60, s58, 8
    v_add_u32 v26, s60, v2
    s_mul_i32 s16, s58, 16384
    s_add_u32 s16, s16, 65536
    s_mul_i32 s17, s36, 7
    s_lshr_b32 s17, s17, 3
    s_lshl_b32 s52, s17, 18
    s_add_u32 m0, s16, 0
    s_nop 0
    buffer_load_dwordx4 v26, s[12:15], s52 offen offset:0 nt lds
    s_add_u32 s52, s52, 64512
    buffer_load_dwordx4 v26, s[12:15], s52 offen offset:1024 nt lds
    s_add_u32 s52, s52, 64512
    buffer_load_dwordx4 v26, s[12:15], s52 offen offset:2048 nt lds
    s_add_u32 s52, s52, 64512
    buffer_load_dwordx4 v26, s[12:15], s52 offen offset:3072 nt lds
    s_mul_i32 s60, s36, 57344
    s_add_u32 s8, s64, s60
    s_addc_u32 s9, s65, 0
    s_mov_b32 s10, 57344
    s_mov_b32 s11, 0x00020000
    s_mul_i32 s60, s58, 896
    s_mov_b32 s61, 76695845
    s_mul_i32 s62, s58, 14336
    v_add_u32 v32, 0, v254
    v_add_u32 v32, s60, v32
    v_mul_hi_u32 v33, v32, s61
    v_mul_u32_u24 v34, 56, v33
    v_sub_u32 v34, v32, v34
    v_bfe_u32 v35, v33, 1, 3
    v_xor_b32 v34, v34, v35
    v_lshlrev_b32 v34, 4, v34
    v_mul_u32_u24 v33, 896, v33
    v_add_u32 v32, v33, v34
    s_add_u32 m0, s62, 0
    s_nop 0
    buffer_load_dwordx4 v32, s[8:11], 0 offen nt lds
    v_add_u32 v36, 64, v254
    v_add_u32 v36, s60, v36
    v_mul_hi_u32 v37, v36, s61
    v_mul_u32_u24 v38, 56, v37
    v_sub_u32 v38, v36, v38
    v_bfe_u32 v39, v37, 1, 3
    v_xor_b32 v38, v38, v39
    v_lshlrev_b32 v38, 4, v38
    v_mul_u32_u24 v37, 896, v37
    v_add_u32 v36, v37, v38
    s_add_u32 m0, s62, 1024
    s_nop 0
    buffer_load_dwordx4 v36, s[8:11], 0 offen nt lds
    v_add_u32 v40, 128, v254
    v_add_u32 v40, s60, v40
    v_mul_hi_u32 v41, v40, s61
    v_mul_u32_u24 v42, 56, v41
    v_sub_u32 v42, v40, v42
    v_bfe_u32 v43, v41, 1, 3
    v_xor_b32 v42, v42, v43
    v_lshlrev_b32 v42, 4, v42
    v_mul_u32_u24 v41, 896, v41
    v_add_u32 v40, v41, v42
    s_add_u32 m0, s62, 2048
    s_nop 0
    buffer_load_dwordx4 v40, s[8:11], 0 offen nt lds
    v_add_u32 v44, 192, v254
    v_add_u32 v44, s60, v44
    v_mul_hi_u32 v45, v44, s61
    v_mul_u32_u24 v46, 56, v45
    v_sub_u32 v46, v44, v46
    v_bfe_u32 v47, v45, 1, 3
    v_xor_b32 v46, v46, v47
    v_lshlrev_b32 v46, 4, v46
    v_mul_u32_u24 v45, 896, v45
    v_add_u32 v44, v45, v46
    s_add_u32 m0, s62, 3072
    s_nop 0
    buffer_load_dwordx4 v44, s[8:11], 0 offen nt lds
    v_add_u32 v48, 256, v254
    v_add_u32 v48, s60, v48
    v_mul_hi_u32 v49, v48, s61
    v_mul_u32_u24 v50, 56, v49
    v_sub_u32 v50, v48, v50
    v_bfe_u32 v51, v49, 1, 3
    v_xor_b32 v50, v50, v51
    v_lshlrev_b32 v50, 4, v50
    v_mul_u32_u24 v49, 896, v49
    v_add_u32 v48, v49, v50
    s_add_u32 m0, s62, 4096
    s_nop 0
    buffer_load_dwordx4 v48, s[8:11], 0 offen nt lds
    v_add_u32 v52, 320, v254
    v_add_u32 v52, s60, v52
    v_mul_hi_u32 v53, v52, s61
    v_mul_u32_u24 v54, 56, v53
    v_sub_u32 v54, v52, v54
    v_bfe_u32 v55, v53, 1, 3
    v_xor_b32 v54, v54, v55
    v_lshlrev_b32 v54, 4, v54
    v_mul_u32_u24 v53, 896, v53
    v_add_u32 v52, v53, v54
    s_add_u32 m0, s62, 5120
    s_nop 0
    buffer_load_dwordx4 v52, s[8:11], 0 offen nt lds
    v_add_u32 v56, 384, v254
    v_add_u32 v56, s60, v56
    v_mul_hi_u32 v57, v56, s61
    v_mul_u32_u24 v58, 56, v57
    v_sub_u32 v58, v56, v58
    v_bfe_u32 v59, v57, 1, 3
    v_xor_b32 v58, v58, v59
    v_lshlrev_b32 v58, 4, v58
    v_mul_u32_u24 v57, 896, v57
    v_add_u32 v56, v57, v58
    s_add_u32 m0, s62, 6144
    s_nop 0
    buffer_load_dwordx4 v56, s[8:11], 0 offen nt lds
    v_add_u32 v60, 448, v254
    v_add_u32 v60, s60, v60
    v_mul_hi_u32 v61, v60, s61
    v_mul_u32_u24 v62, 56, v61
    v_sub_u32 v62, v60, v62
    v_bfe_u32 v63, v61, 1, 3
    v_xor_b32 v62, v62, v63
    v_lshlrev_b32 v62, 4, v62
    v_mul_u32_u24 v61, 896, v61
    v_add_u32 v60, v61, v62
    s_add_u32 m0, s62, 7168
    s_nop 0
    buffer_load_dwordx4 v60, s[8:11], 0 offen nt lds
    v_add_u32 v64, 512, v254
    v_add_u32 v64, s60, v64
    v_mul_hi_u32 v65, v64, s61
    v_mul_u32_u24 v66, 56, v65
    v_sub_u32 v66, v64, v66
    v_bfe_u32 v67, v65, 1, 3
    v_xor_b32 v66, v66, v67
    v_lshlrev_b32 v66, 4, v66
    v_mul_u32_u24 v65, 896, v65
    v_add_u32 v64, v65, v66
    s_add_u32 m0, s62, 8192
    s_nop 0
    buffer_load_dwordx4 v64, s[8:11], 0 offen nt lds
    v_add_u32 v68, 576, v254
    v_add_u32 v68, s60, v68
    v_mul_hi_u32 v69, v68, s61
    v_mul_u32_u24 v70, 56, v69
    v_sub_u32 v70, v68, v70
    v_bfe_u32 v71, v69, 1, 3
    v_xor_b32 v70, v70, v71
    v_lshlrev_b32 v70, 4, v70
    v_mul_u32_u24 v69, 896, v69
    v_add_u32 v68, v69, v70
    s_add_u32 m0, s62, 9216
    s_nop 0
    buffer_load_dwordx4 v68, s[8:11], 0 offen nt lds
    v_add_u32 v72, 640, v254
    v_add_u32 v72, s60, v72
    v_mul_hi_u32 v73, v72, s61
    v_mul_u32_u24 v74, 56, v73
    v_sub_u32 v74, v72, v74
    v_bfe_u32 v75, v73, 1, 3
    v_xor_b32 v74, v74, v75
    v_lshlrev_b32 v74, 4, v74
    v_mul_u32_u24 v73, 896, v73
    v_add_u32 v72, v73, v74
    s_add_u32 m0, s62, 10240
    s_nop 0
    buffer_load_dwordx4 v72, s[8:11], 0 offen nt lds
    v_add_u32 v76, 704, v254
    v_add_u32 v76, s60, v76
    v_mul_hi_u32 v77, v76, s61
    v_mul_u32_u24 v78, 56, v77
    v_sub_u32 v78, v76, v78
    v_bfe_u32 v79, v77, 1, 3
    v_xor_b32 v78, v78, v79
    v_lshlrev_b32 v78, 4, v78
    v_mul_u32_u24 v77, 896, v77
    v_add_u32 v76, v77, v78
    s_add_u32 m0, s62, 11264
    s_nop 0
    buffer_load_dwordx4 v76, s[8:11], 0 offen nt lds
    v_add_u32 v80, 768, v254
    v_add_u32 v80, s60, v80
    v_mul_hi_u32 v81, v80, s61
    v_mul_u32_u24 v82, 56, v81
    v_sub_u32 v82, v80, v82
    v_bfe_u32 v83, v81, 1, 3
    v_xor_b32 v82, v82, v83
    v_lshlrev_b32 v82, 4, v82
    v_mul_u32_u24 v81, 896, v81
    v_add_u32 v80, v81, v82
    s_add_u32 m0, s62, 12288
    s_nop 0
    buffer_load_dwordx4 v80, s[8:11], 0 offen nt lds
    v_add_u32 v84, 832, v254
    v_add_u32 v84, s60, v84
    v_mul_hi_u32 v85, v84, s61
    v_mul_u32_u24 v86, 56, v85
    v_sub_u32 v86, v84, v86
    v_bfe_u32 v87, v85, 1, 3
    v_xor_b32 v86, v86, v87
    v_lshlrev_b32 v86, 4, v86
    v_mul_u32_u24 v85, 896, v85
    v_add_u32 v84, v85, v86
    s_add_u32 m0, s62, 13312
    s_nop 0
    buffer_load_dwordx4 v84, s[8:11], 0 offen nt lds
    s_lshl_b32 s52, s17, 18
    s_add_u32 s52, s52, 128
    s_add_u32 s17, s17, 1
    s_cmp_ge_u32 s17, 14
    s_cselect_b32 s17, 0, s17
    s_add_u32 m0, s16, 4096
    s_nop 0
    buffer_load_dwordx4 v26, s[12:15], s52 offen offset:0 nt lds
    s_add_u32 s52, s52, 64512
    buffer_load_dwordx4 v26, s[12:15], s52 offen offset:1024 nt lds
    s_add_u32 s52, s52, 64512
    buffer_load_dwordx4 v26, s[12:15], s52 offen offset:2048 nt lds
    s_add_u32 s52, s52, 64512
    buffer_load_dwordx4 v26, s[12:15], s52 offen offset:3072 nt lds
    s_lshl_b32 s52, s17, 18
    s_add_u32 m0, s16, 8192
    s_nop 0
    buffer_load_dwordx4 v26, s[12:15], s52 offen offset:0 nt lds
    s_add_u32 s52, s52, 64512
    buffer_load_dwordx4 v26, s[12:15], s52 offen offset:1024 nt lds
    s_add_u32 s52, s52, 64512
    buffer_load_dwordx4 v26, s[12:15], s52 offen offset:2048 nt lds
    s_add_u32 s52, s52, 64512
    buffer_load_dwordx4 v26, s[12:15], s52 offen offset:3072 nt lds
    s_lshl_b32 s52, s17, 18
    s_add_u32 s52, s52, 128
    s_add_u32 s17, s17, 1
    s_cmp_ge_u32 s17, 14
    s_cselect_b32 s17, 0, s17
    s_add_u32 m0, s16, 12288
    s_nop 0
    buffer_load_dwordx4 v26, s[12:15], s52 offen offset:0 nt lds
    s_add_u32 s52, s52, 64512
    buffer_load_dwordx4 v26, s[12:15], s52 offen offset:1024 nt lds
    s_add_u32 s52, s52, 64512
    buffer_load_dwordx4 v26, s[12:15], s52 offen offset:2048 nt lds
    s_add_u32 s52, s52, 64512
    buffer_load_dwordx4 v26, s[12:15], s52 offen offset:3072 nt lds
    s_lshl_b32 s60, s36, 22
    s_lshl_b32 s61, s35, 19
    s_add_u32 s60, s60, s61
    s_add_u32 s40, s66, s60
    s_addc_u32 s41, s67, 0
    s_mov_b32 s42, 524288
    s_mov_b32 s43, 0x00020000
    s_add_u32 s44, s68, s60
    s_addc_u32 s45, s69, 0
    s_mov_b32 s46, 524288
    s_mov_b32 s47, 0x00020000
    s_mul_i32 s60, s35, 458752
    s_add_u32 s48, s72, s60
    s_addc_u32 s49, s73, 0
    s_mov_b32 s50, 458752
    s_mov_b32 s51, 0x00020000
    v_lshrrev_b32 v2, 5, v254
    v_and_b32 v3, 31, v254
    s_lshl_b32 s60, s58, 3
    v_add_u32 v4, s60, v2
    v_lshlrev_b32 v5, 9, v4
    v_add_u32 v6, 0, v4
    v_and_b32 v7, 15, v6
    v_xor_b32 v7, v7, v3
    v_lshlrev_b32 v7, 4, v7
    v_add_u32 v10, v5, v7
    v_and_b32 v7, 7, v6
    v_lshlrev_b32 v7, 1, v7
    v_xor_b32 v7, v7, v3
    v_lshlrev_b32 v7, 4, v7
    v_add_u32 v14, v5, v7
    v_add_u32 v6, 2, v4
    v_and_b32 v7, 15, v6
    v_xor_b32 v7, v7, v3
    v_lshlrev_b32 v7, 4, v7
    v_add_u32 v11, v5, v7
    v_and_b32 v7, 7, v6
    v_lshlrev_b32 v7, 1, v7
    v_xor_b32 v7, v7, v3
    v_lshlrev_b32 v7, 4, v7
    v_add_u32 v15, v5, v7
    v_add_u32 v6, 4, v4
    v_and_b32 v7, 15, v6
    v_xor_b32 v7, v7, v3
    v_lshlrev_b32 v7, 4, v7
    v_add_u32 v12, v5, v7
    v_and_b32 v7, 7, v6
    v_lshlrev_b32 v7, 1, v7
    v_xor_b32 v7, v7, v3
    v_lshlrev_b32 v7, 4, v7
    v_add_u32 v16, v5, v7
    v_add_u32 v6, 6, v4
    v_and_b32 v7, 15, v6
    v_xor_b32 v7, v7, v3
    v_lshlrev_b32 v7, 4, v7
    v_add_u32 v13, v5, v7
    v_and_b32 v7, 7, v6
    v_lshlrev_b32 v7, 1, v7
    v_xor_b32 v7, v7, v3
    v_lshlrev_b32 v7, 4, v7
    v_add_u32 v17, v5, v7
    s_mul_i32 s60, s58, 448
    s_mov_b32 s61, 76695845
    v_add_u32 v6, 0, v254
    v_add_u32 v6, s60, v6
    v_mul_hi_u32 v7, v6, s61
    v_mul_u32_u24 v8, 56, v7
    v_sub_u32 v8, v6, v8
    v_bfe_u32 v9, v7, 1, 2
    v_lshlrev_b32 v9, 1, v9
    v_xor_b32 v8, v8, v9
    v_lshlrev_b32 v8, 4, v8
    v_mul_u32_u24 v7, 896, v7
    v_add_u32 v18, v7, v8
    v_add_u32 v6, 64, v254
    v_add_u32 v6, s60, v6
    v_mul_hi_u32 v7, v6, s61
    v_mul_u32_u24 v8, 56, v7
    v_sub_u32 v8, v6, v8
    v_bfe_u32 v9, v7, 1, 2
    v_lshlrev_b32 v9, 1, v9
    v_xor_b32 v8, v8, v9
    v_lshlrev_b32 v8, 4, v8
    v_mul_u32_u24 v7, 896, v7
    v_add_u32 v19, v7, v8
    v_add_u32 v6, 128, v254
    v_add_u32 v6, s60, v6
    v_mul_hi_u32 v7, v6, s61
    v_mul_u32_u24 v8, 56, v7
    v_sub_u32 v8, v6, v8
    v_bfe_u32 v9, v7, 1, 2
    v_lshlrev_b32 v9, 1, v9
    v_xor_b32 v8, v8, v9
    v_lshlrev_b32 v8, 4, v8
    v_mul_u32_u24 v7, 896, v7
    v_add_u32 v20, v7, v8
    v_add_u32 v6, 192, v254
    v_add_u32 v6, s60, v6
    v_mul_hi_u32 v7, v6, s61
    v_mul_u32_u24 v8, 56, v7
    v_sub_u32 v8, v6, v8
    v_bfe_u32 v9, v7, 1, 2
    v_lshlrev_b32 v9, 1, v9
    v_xor_b32 v8, v8, v9
    v_lshlrev_b32 v8, 4, v8
    v_mul_u32_u24 v7, 896, v7
    v_add_u32 v21, v7, v8
    v_add_u32 v6, 256, v254
    v_add_u32 v6, s60, v6
    v_mul_hi_u32 v7, v6, s61
    v_mul_u32_u24 v8, 56, v7
    v_sub_u32 v8, v6, v8
    v_bfe_u32 v9, v7, 1, 2
    v_lshlrev_b32 v9, 1, v9
    v_xor_b32 v8, v8, v9
    v_lshlrev_b32 v8, 4, v8
    v_mul_u32_u24 v7, 896, v7
    v_add_u32 v22, v7, v8
    v_add_u32 v6, 320, v254
    v_add_u32 v6, s60, v6
    v_mul_hi_u32 v7, v6, s61
    v_mul_u32_u24 v8, 56, v7
    v_sub_u32 v8, v6, v8
    v_bfe_u32 v9, v7, 1, 2
    v_lshlrev_b32 v9, 1, v9
    v_xor_b32 v8, v8, v9
    v_lshlrev_b32 v8, 4, v8
    v_mul_u32_u24 v7, 896, v7
    v_add_u32 v23, v7, v8
    v_add_u32 v6, 384, v254
    v_add_u32 v6, s60, v6
    v_mul_hi_u32 v7, v6, s61
    v_mul_u32_u24 v8, 56, v7
    v_sub_u32 v8, v6, v8
    v_bfe_u32 v9, v7, 1, 2
    v_lshlrev_b32 v9, 1, v9
    v_xor_b32 v8, v8, v9
    v_lshlrev_b32 v8, 4, v8
    v_mul_u32_u24 v7, 896, v7
    v_add_u32 v24, v7, v8
    s_lshl_b32 s53, s58, 12
    s_mul_i32 s63, s58, 7168
    s_mov_b32 s96, s36
    s_waitcnt vmcnt(12)
    s_barrier
    s_waitcnt vmcnt(8)
    s_barrier
    s_lshl_b32 s52, s17, 18
    s_add_u32 m0, s16, 0
    s_nop 0
    buffer_load_dwordx4 v26, s[12:15], s52 offen offset:0 nt lds
    s_add_u32 s52, s52, 64512
    buffer_load_dwordx4 v26, s[12:15], s52 offen offset:1024 nt lds
    s_add_u32 s52, s52, 64512
    buffer_load_dwordx4 v26, s[12:15], s52 offen offset:2048 nt lds
    s_add_u32 s52, s52, 64512
    buffer_load_dwordx4 v26, s[12:15], s52 offen offset:3072 nt lds
    s_waitcnt vmcnt(8)
    s_barrier
    s_lshl_b32 s52, s17, 18
    s_add_u32 s52, s52, 128
    s_add_u32 s17, s17, 1
    s_cmp_ge_u32 s17, 14
    s_cselect_b32 s17, 0, s17
    s_add_u32 m0, s16, 4096
    s_nop 0
    buffer_load_dwordx4 v26, s[12:15], s52 offen offset:0 nt lds
    s_add_u32 s52, s52, 64512
    buffer_load_dwordx4 v26, s[12:15], s52 offen offset:1024 nt lds
    s_add_u32 s52, s52, 64512
    buffer_load_dwordx4 v26, s[12:15], s52 offen offset:2048 nt lds
    s_add_u32 s52, s52, 64512
    buffer_load_dwordx4 v26, s[12:15], s52 offen offset:3072 nt lds
    s_waitcnt vmcnt(8)
    s_barrier
    s_lshl_b32 s52, s17, 18
    s_add_u32 m0, s16, 8192
    s_nop 0
    buffer_load_dwordx4 v26, s[12:15], s52 offen offset:0 nt lds
    s_add_u32 s52, s52, 64512
    buffer_load_dwordx4 v26, s[12:15], s52 offen offset:1024 nt lds
    s_add_u32 s52, s52, 64512
    buffer_load_dwordx4 v26, s[12:15], s52 offen offset:2048 nt lds
    s_add_u32 s52, s52, 64512
    buffer_load_dwordx4 v26, s[12:15], s52 offen offset:3072 nt lds
    s_waitcnt vmcnt(8)
    s_barrier
    s_lshl_b32 s52, s17, 18
    s_add_u32 s52, s52, 128
    s_add_u32 s17, s17, 1
    s_cmp_ge_u32 s17, 14
    s_cselect_b32 s17, 0, s17
    s_add_u32 m0, s16, 12288
    s_nop 0
    buffer_load_dwordx4 v26, s[12:15], s52 offen offset:0 nt lds
    s_add_u32 s52, s52, 64512
    buffer_load_dwordx4 v26, s[12:15], s52 offen offset:1024 nt lds
    s_add_u32 s52, s52, 64512
    buffer_load_dwordx4 v26, s[12:15], s52 offen offset:2048 nt lds
    s_add_u32 s52, s52, 64512
    buffer_load_dwordx4 v26, s[12:15], s52 offen offset:3072 nt lds
    s_waitcnt vmcnt(8)
    s_barrier
    s_lshl_b32 s52, s17, 18
    s_add_u32 m0, s16, 0
    s_nop 0
    buffer_load_dwordx4 v26, s[12:15], s52 offen offset:0 nt lds
    s_add_u32 s52, s52, 64512
    buffer_load_dwordx4 v26, s[12:15], s52 offen offset:1024 nt lds
    s_add_u32 s52, s52, 64512
    buffer_load_dwordx4 v26, s[12:15], s52 offen offset:2048 nt lds
    s_add_u32 s52, s52, 64512
    buffer_load_dwordx4 v26, s[12:15], s52 offen offset:3072 nt lds
    s_waitcnt vmcnt(8)
    s_barrier
    s_lshl_b32 s52, s17, 18
    s_add_u32 s52, s52, 128
    s_add_u32 s17, s17, 1
    s_cmp_ge_u32 s17, 14
    s_cselect_b32 s17, 0, s17
    s_add_u32 m0, s16, 4096
    s_nop 0
    buffer_load_dwordx4 v26, s[12:15], s52 offen offset:0 nt lds
    s_add_u32 s52, s52, 64512
    buffer_load_dwordx4 v26, s[12:15], s52 offen offset:1024 nt lds
    s_add_u32 s52, s52, 64512
    buffer_load_dwordx4 v26, s[12:15], s52 offen offset:2048 nt lds
    s_add_u32 s52, s52, 64512
    buffer_load_dwordx4 v26, s[12:15], s52 offen offset:3072 nt lds
    s_waitcnt vmcnt(8)
    s_barrier
    s_lshl_b32 s52, s17, 18
    s_add_u32 m0, s16, 8192
    s_nop 0
    buffer_load_dwordx4 v26, s[12:15], s52 offen offset:0 nt lds
    s_add_u32 s52, s52, 64512
    buffer_load_dwordx4 v26, s[12:15], s52 offen offset:1024 nt lds
    s_add_u32 s52, s52, 64512
    buffer_load_dwordx4 v26, s[12:15], s52 offen offset:2048 nt lds
    s_add_u32 s52, s52, 64512
    buffer_load_dwordx4 v26, s[12:15], s52 offen offset:3072 nt lds
    s_waitcnt vmcnt(8)
    s_barrier
    s_lshl_b32 s52, s17, 18
    s_add_u32 s52, s52, 128
    s_add_u32 s17, s17, 1
    s_cmp_ge_u32 s17, 14
    s_cselect_b32 s17, 0, s17
    s_add_u32 m0, s16, 12288
    s_nop 0
    buffer_load_dwordx4 v26, s[12:15], s52 offen offset:0 nt lds
    s_add_u32 s52, s52, 64512
    buffer_load_dwordx4 v26, s[12:15], s52 offen offset:1024 nt lds
    s_add_u32 s52, s52, 64512
    buffer_load_dwordx4 v26, s[12:15], s52 offen offset:2048 nt lds
    s_add_u32 s52, s52, 64512
    buffer_load_dwordx4 v26, s[12:15], s52 offen offset:3072 nt lds
    s_waitcnt vmcnt(8)
    s_barrier
    s_lshl_b32 s52, s17, 18
    s_add_u32 m0, s16, 0
    s_nop 0
    buffer_load_dwordx4 v26, s[12:15], s52 offen offset:0 nt lds
    s_add_u32 s52, s52, 64512
    buffer_load_dwordx4 v26, s[12:15], s52 offen offset:1024 nt lds
    s_add_u32 s52, s52, 64512
    buffer_load_dwordx4 v26, s[12:15], s52 offen offset:2048 nt lds
    s_add_u32 s52, s52, 64512
    buffer_load_dwordx4 v26, s[12:15], s52 offen offset:3072 nt lds
    s_waitcnt vmcnt(8)
    s_barrier
    s_lshl_b32 s52, s17, 18
    s_add_u32 s52, s52, 128
    s_add_u32 s17, s17, 1
    s_cmp_ge_u32 s17, 14
    s_cselect_b32 s17, 0, s17
    s_add_u32 m0, s16, 4096
    s_nop 0
    buffer_load_dwordx4 v26, s[12:15], s52 offen offset:0 nt lds
    s_add_u32 s52, s52, 64512
    buffer_load_dwordx4 v26, s[12:15], s52 offen offset:1024 nt lds
    s_add_u32 s52, s52, 64512
    buffer_load_dwordx4 v26, s[12:15], s52 offen offset:2048 nt lds
    s_add_u32 s52, s52, 64512
    buffer_load_dwordx4 v26, s[12:15], s52 offen offset:3072 nt lds
    s_waitcnt vmcnt(8)
    s_barrier
    s_lshl_b32 s52, s17, 18
    s_add_u32 m0, s16, 8192
    s_nop 0
    buffer_load_dwordx4 v26, s[12:15], s52 offen offset:0 nt lds
    s_add_u32 s52, s52, 64512
    buffer_load_dwordx4 v26, s[12:15], s52 offen offset:1024 nt lds
    s_add_u32 s52, s52, 64512
    buffer_load_dwordx4 v26, s[12:15], s52 offen offset:2048 nt lds
    s_add_u32 s52, s52, 64512
    buffer_load_dwordx4 v26, s[12:15], s52 offen offset:3072 nt lds
    s_waitcnt vmcnt(8)
    s_barrier
    s_lshl_b32 s52, s17, 18
    s_add_u32 s52, s52, 128
    s_add_u32 s17, s17, 1
    s_cmp_ge_u32 s17, 14
    s_cselect_b32 s17, 0, s17
    s_add_u32 m0, s16, 12288
    s_nop 0
    buffer_load_dwordx4 v26, s[12:15], s52 offen offset:0 nt lds
    s_add_u32 s52, s52, 64512
    buffer_load_dwordx4 v26, s[12:15], s52 offen offset:1024 nt lds
    s_add_u32 s52, s52, 64512
    buffer_load_dwordx4 v26, s[12:15], s52 offen offset:2048 nt lds
    s_add_u32 s52, s52, 64512
    buffer_load_dwordx4 v26, s[12:15], s52 offen offset:3072 nt lds
    s_waitcnt vmcnt(8)
    s_barrier
    s_lshl_b32 s52, s17, 18
    s_add_u32 m0, s16, 0
    s_nop 0
    buffer_load_dwordx4 v26, s[12:15], s52 offen offset:0 nt lds
    s_add_u32 s52, s52, 64512
    buffer_load_dwordx4 v26, s[12:15], s52 offen offset:1024 nt lds
    s_add_u32 s52, s52, 64512
    buffer_load_dwordx4 v26, s[12:15], s52 offen offset:2048 nt lds
    s_add_u32 s52, s52, 64512
    buffer_load_dwordx4 v26, s[12:15], s52 offen offset:3072 nt lds
    s_waitcnt vmcnt(8)
    s_barrier
    s_lshl_b32 s52, s17, 18
    s_add_u32 s52, s52, 128
    s_add_u32 s17, s17, 1
    s_cmp_ge_u32 s17, 14
    s_cselect_b32 s17, 0, s17
    s_add_u32 m0, s16, 4096
    s_nop 0
    buffer_load_dwordx4 v26, s[12:15], s52 offen offset:0 nt lds
    s_add_u32 s52, s52, 64512
    buffer_load_dwordx4 v26, s[12:15], s52 offen offset:1024 nt lds
    s_add_u32 s52, s52, 64512
    buffer_load_dwordx4 v26, s[12:15], s52 offen offset:2048 nt lds
    s_add_u32 s52, s52, 64512
    buffer_load_dwordx4 v26, s[12:15], s52 offen offset:3072 nt lds
    s_waitcnt vmcnt(8)
    s_barrier
    s_lshl_b32 s52, s17, 18
    s_add_u32 m0, s16, 8192
    s_nop 0
    buffer_load_dwordx4 v26, s[12:15], s52 offen offset:0 nt lds
    s_add_u32 s52, s52, 64512
    buffer_load_dwordx4 v26, s[12:15], s52 offen offset:1024 nt lds
    s_add_u32 s52, s52, 64512
    buffer_load_dwordx4 v26, s[12:15], s52 offen offset:2048 nt lds
    s_add_u32 s52, s52, 64512
    buffer_load_dwordx4 v26, s[12:15], s52 offen offset:3072 nt lds
    s_waitcnt vmcnt(8)
    s_barrier
    s_lshl_b32 s52, s17, 18
    s_add_u32 s52, s52, 128
    s_add_u32 s17, s17, 1
    s_cmp_ge_u32 s17, 14
    s_cselect_b32 s17, 0, s17
    s_add_u32 m0, s16, 12288
    s_nop 0
    buffer_load_dwordx4 v26, s[12:15], s52 offen offset:0 nt lds
    s_add_u32 s52, s52, 64512
    buffer_load_dwordx4 v26, s[12:15], s52 offen offset:1024 nt lds
    s_add_u32 s52, s52, 64512
    buffer_load_dwordx4 v26, s[12:15], s52 offen offset:2048 nt lds
    s_add_u32 s52, s52, 64512
    buffer_load_dwordx4 v26, s[12:15], s52 offen offset:3072 nt lds
    s_waitcnt vmcnt(8)
    s_barrier
    s_lshl_b32 s52, s17, 18
    s_add_u32 m0, s16, 0
    s_nop 0
    buffer_load_dwordx4 v26, s[12:15], s52 offen offset:0 nt lds
    s_add_u32 s52, s52, 64512
    buffer_load_dwordx4 v26, s[12:15], s52 offen offset:1024 nt lds
    s_add_u32 s52, s52, 64512
    buffer_load_dwordx4 v26, s[12:15], s52 offen offset:2048 nt lds
    s_add_u32 s52, s52, 64512
    buffer_load_dwordx4 v26, s[12:15], s52 offen offset:3072 nt lds
    s_waitcnt vmcnt(8)
    s_barrier
    s_lshl_b32 s52, s17, 18
    s_add_u32 s52, s52, 128
    s_add_u32 s17, s17, 1
    s_cmp_ge_u32 s17, 14
    s_cselect_b32 s17, 0, s17
    s_add_u32 m0, s16, 4096
    s_nop 0
    buffer_load_dwordx4 v26, s[12:15], s52 offen offset:0 nt lds
    s_add_u32 s52, s52, 64512
    buffer_load_dwordx4 v26, s[12:15], s52 offen offset:1024 nt lds
    s_add_u32 s52, s52, 64512
    buffer_load_dwordx4 v26, s[12:15], s52 offen offset:2048 nt lds
    s_add_u32 s52, s52, 64512
    buffer_load_dwordx4 v26, s[12:15], s52 offen offset:3072 nt lds
    s_waitcnt vmcnt(8)
    s_barrier
    s_lshl_b32 s52, s17, 18
    s_add_u32 m0, s16, 8192
    s_nop 0
    buffer_load_dwordx4 v26, s[12:15], s52 offen offset:0 nt lds
    s_add_u32 s52, s52, 64512
    buffer_load_dwordx4 v26, s[12:15], s52 offen offset:1024 nt lds
    s_add_u32 s52, s52, 64512
    buffer_load_dwordx4 v26, s[12:15], s52 offen offset:2048 nt lds
    s_add_u32 s52, s52, 64512
    buffer_load_dwordx4 v26, s[12:15], s52 offen offset:3072 nt lds
    s_waitcnt vmcnt(8)
    s_barrier
    s_lshl_b32 s52, s17, 18
    s_add_u32 s52, s52, 128
    s_add_u32 s17, s17, 1
    s_cmp_ge_u32 s17, 14
    s_cselect_b32 s17, 0, s17
    s_add_u32 m0, s16, 12288
    s_nop 0
    buffer_load_dwordx4 v26, s[12:15], s52 offen offset:0 nt lds
    s_add_u32 s52, s52, 64512
    buffer_load_dwordx4 v26, s[12:15], s52 offen offset:1024 nt lds
    s_add_u32 s52, s52, 64512
    buffer_load_dwordx4 v26, s[12:15], s52 offen offset:2048 nt lds
    s_add_u32 s52, s52, 64512
    buffer_load_dwordx4 v26, s[12:15], s52 offen offset:3072 nt lds
    s_waitcnt vmcnt(8)
    s_barrier
    s_lshl_b32 s52, s17, 18
    s_add_u32 m0, s16, 0
    s_nop 0
    buffer_load_dwordx4 v26, s[12:15], s52 offen offset:0 nt lds
    s_add_u32 s52, s52, 64512
    buffer_load_dwordx4 v26, s[12:15], s52 offen offset:1024 nt lds
    s_add_u32 s52, s52, 64512
    buffer_load_dwordx4 v26, s[12:15], s52 offen offset:2048 nt lds
    s_add_u32 s52, s52, 64512
    buffer_load_dwordx4 v26, s[12:15], s52 offen offset:3072 nt lds
    s_waitcnt vmcnt(8)
    s_barrier
    s_lshl_b32 s52, s17, 18
    s_add_u32 s52, s52, 128
    s_add_u32 s17, s17, 1
    s_cmp_ge_u32 s17, 14
    s_cselect_b32 s17, 0, s17
    s_add_u32 m0, s16, 4096
    s_nop 0
    buffer_load_dwordx4 v26, s[12:15], s52 offen offset:0 nt lds
    s_add_u32 s52, s52, 64512
    buffer_load_dwordx4 v26, s[12:15], s52 offen offset:1024 nt lds
    s_add_u32 s52, s52, 64512
    buffer_load_dwordx4 v26, s[12:15], s52 offen offset:2048 nt lds
    s_add_u32 s52, s52, 64512
    buffer_load_dwordx4 v26, s[12:15], s52 offen offset:3072 nt lds
    s_waitcnt vmcnt(8)
    s_barrier
    s_lshl_b32 s52, s17, 18
    s_add_u32 m0, s16, 8192
    s_nop 0
    buffer_load_dwordx4 v26, s[12:15], s52 offen offset:0 nt lds
    s_add_u32 s52, s52, 64512
    buffer_load_dwordx4 v26, s[12:15], s52 offen offset:1024 nt lds
    s_add_u32 s52, s52, 64512
    buffer_load_dwordx4 v26, s[12:15], s52 offen offset:2048 nt lds
    s_add_u32 s52, s52, 64512
    buffer_load_dwordx4 v26, s[12:15], s52 offen offset:3072 nt lds
    s_waitcnt vmcnt(8)
    s_barrier
    s_lshl_b32 s52, s17, 18
    s_add_u32 s52, s52, 128
    s_add_u32 s17, s17, 1
    s_cmp_ge_u32 s17, 14
    s_cselect_b32 s17, 0, s17
    s_add_u32 m0, s16, 12288
    s_nop 0
    buffer_load_dwordx4 v26, s[12:15], s52 offen offset:0 nt lds
    s_add_u32 s52, s52, 64512
    buffer_load_dwordx4 v26, s[12:15], s52 offen offset:1024 nt lds
    s_add_u32 s52, s52, 64512
    buffer_load_dwordx4 v26, s[12:15], s52 offen offset:2048 nt lds
    s_add_u32 s52, s52, 64512
    buffer_load_dwordx4 v26, s[12:15], s52 offen offset:3072 nt lds
    s_mov_b32 s52, 0
    s_add_u32 m0, s53, 131072
    s_nop 0
    buffer_load_dwordx4 v10, s[40:43], s52 offen offset:0 nt lds
    buffer_load_dwordx4 v11, s[40:43], s52 offen offset:1024 nt lds
    buffer_load_dwordx4 v12, s[40:43], s52 offen offset:2048 nt lds
    buffer_load_dwordx4 v13, s[40:43], s52 offen offset:3072 nt lds
    s_add_u32 m0, s53, 147456
    s_nop 0
    buffer_load_dwordx4 v14, s[44:47], s52 offen offset:0 nt lds
    buffer_load_dwordx4 v15, s[44:47], s52 offen offset:1024 nt lds
    buffer_load_dwordx4 v16, s[44:47], s52 offen offset:2048 nt lds
    buffer_load_dwordx4 v17, s[44:47], s52 offen offset:3072 nt lds
    s_waitcnt vmcnt(16)
    s_barrier
    s_waitcnt vmcnt(12)
    s_barrier
    s_waitcnt vmcnt(8)
    s_barrier
    s_barrier
    s_mov_b32 s52, 16384
    s_add_u32 m0, s53, 0
    s_nop 0
    buffer_load_dwordx4 v10, s[40:43], s52 offen offset:0 nt lds
    buffer_load_dwordx4 v11, s[40:43], s52 offen offset:1024 nt lds
    buffer_load_dwordx4 v12, s[40:43], s52 offen offset:2048 nt lds
    buffer_load_dwordx4 v13, s[40:43], s52 offen offset:3072 nt lds
    s_add_u32 m0, s53, 16384
    s_nop 0
    buffer_load_dwordx4 v14, s[44:47], s52 offen offset:0 nt lds
    buffer_load_dwordx4 v15, s[44:47], s52 offen offset:1024 nt lds
    buffer_load_dwordx4 v16, s[44:47], s52 offen offset:2048 nt lds
    buffer_load_dwordx4 v17, s[44:47], s52 offen offset:3072 nt lds
    s_mov_b32 s52, 32768
    s_add_u32 m0, s53, 32768
    s_nop 0
    buffer_load_dwordx4 v10, s[40:43], s52 offen offset:0 nt lds
    buffer_load_dwordx4 v11, s[40:43], s52 offen offset:1024 nt lds
    buffer_load_dwordx4 v12, s[40:43], s52 offen offset:2048 nt lds
    buffer_load_dwordx4 v13, s[40:43], s52 offen offset:3072 nt lds
    s_add_u32 m0, s53, 49152
    s_nop 0
    buffer_load_dwordx4 v14, s[44:47], s52 offen offset:0 nt lds
    buffer_load_dwordx4 v15, s[44:47], s52 offen offset:1024 nt lds
    buffer_load_dwordx4 v16, s[44:47], s52 offen offset:2048 nt lds
    buffer_load_dwordx4 v17, s[44:47], s52 offen offset:3072 nt lds
    s_barrier
    s_mov_b32 s52, 49152
    s_add_u32 m0, s53, 65536
    s_nop 0
    buffer_load_dwordx4 v10, s[40:43], s52 offen offset:0 nt lds
    buffer_load_dwordx4 v11, s[40:43], s52 offen offset:1024 nt lds
    buffer_load_dwordx4 v12, s[40:43], s52 offen offset:2048 nt lds
    buffer_load_dwordx4 v13, s[40:43], s52 offen offset:3072 nt lds
    s_add_u32 m0, s53, 81920
    s_nop 0
    buffer_load_dwordx4 v14, s[44:47], s52 offen offset:0 nt lds
    buffer_load_dwordx4 v15, s[44:47], s52 offen offset:1024 nt lds
    buffer_load_dwordx4 v16, s[44:47], s52 offen offset:2048 nt lds
    buffer_load_dwordx4 v17, s[44:47], s52 offen offset:3072 nt lds
    s_mov_b32 s52, 65536
    s_add_u32 m0, s53, 98304
    s_nop 0
    buffer_load_dwordx4 v10, s[40:43], s52 offen offset:0 nt lds
    buffer_load_dwordx4 v11, s[40:43], s52 offen offset:1024 nt lds
    buffer_load_dwordx4 v12, s[40:43], s52 offen offset:2048 nt lds
    buffer_load_dwordx4 v13, s[40:43], s52 offen offset:3072 nt lds
    s_add_u32 m0, s53, 114688
    s_nop 0
    buffer_load_dwordx4 v14, s[44:47], s52 offen offset:0 nt lds
    buffer_load_dwordx4 v15, s[44:47], s52 offen offset:1024 nt lds
    buffer_load_dwordx4 v16, s[44:47], s52 offen offset:2048 nt lds
    buffer_load_dwordx4 v17, s[44:47], s52 offen offset:3072 nt lds
    s_waitcnt vmcnt(32)
    s_barrier
    s_waitcnt vmcnt(24)
    s_barrier
    s_mov_b32 s52, 81920
    s_add_u32 m0, s53, 131072
    s_nop 0
    buffer_load_dwordx4 v10, s[40:43], s52 offen offset:0 nt lds
    buffer_load_dwordx4 v11, s[40:43], s52 offen offset:1024 nt lds
    buffer_load_dwordx4 v12, s[40:43], s52 offen offset:2048 nt lds
    buffer_load_dwordx4 v13, s[40:43], s52 offen offset:3072 nt lds
    s_add_u32 m0, s53, 147456
    s_nop 0
    buffer_load_dwordx4 v14, s[44:47], s52 offen offset:0 nt lds
    buffer_load_dwordx4 v15, s[44:47], s52 offen offset:1024 nt lds
    buffer_load_dwordx4 v16, s[44:47], s52 offen offset:2048 nt lds
    buffer_load_dwordx4 v17, s[44:47], s52 offen offset:3072 nt lds
    s_waitcnt vmcnt(24)
    s_barrier
    s_mov_b32 s52, 98304
    s_add_u32 m0, s53, 0
    s_nop 0
    buffer_load_dwordx4 v10, s[40:43], s52 offen offset:0 nt lds
    buffer_load_dwordx4 v11, s[40:43], s52 offen offset:1024 nt lds
    buffer_load_dwordx4 v12, s[40:43], s52 offen offset:2048 nt lds
    buffer_load_dwordx4 v13, s[40:43], s52 offen offset:3072 nt lds
    s_add_u32 m0, s53, 16384
    s_nop 0
    buffer_load_dwordx4 v14, s[44:47], s52 offen offset:0 nt lds
    buffer_load_dwordx4 v15, s[44:47], s52 offen offset:1024 nt lds
    buffer_load_dwordx4 v16, s[44:47], s52 offen offset:2048 nt lds
    buffer_load_dwordx4 v17, s[44:47], s52 offen offset:3072 nt lds
    s_waitcnt vmcnt(24)
    s_barrier
    s_mov_b32 s52, 114688
    s_add_u32 m0, s53, 32768
    s_nop 0
    buffer_load_dwordx4 v10, s[40:43], s52 offen offset:0 nt lds
    buffer_load_dwordx4 v11, s[40:43], s52 offen offset:1024 nt lds
    buffer_load_dwordx4 v12, s[40:43], s52 offen offset:2048 nt lds
    buffer_load_dwordx4 v13, s[40:43], s52 offen offset:3072 nt lds
    s_add_u32 m0, s53, 49152
    s_nop 0
    buffer_load_dwordx4 v14, s[44:47], s52 offen offset:0 nt lds
    buffer_load_dwordx4 v15, s[44:47], s52 offen offset:1024 nt lds
    buffer_load_dwordx4 v16, s[44:47], s52 offen offset:2048 nt lds
    buffer_load_dwordx4 v17, s[44:47], s52 offen offset:3072 nt lds
    s_waitcnt vmcnt(24)
    s_barrier
    s_mov_b32 s52, 131072
    s_add_u32 m0, s53, 65536
    s_nop 0
    buffer_load_dwordx4 v10, s[40:43], s52 offen offset:0 nt lds
    buffer_load_dwordx4 v11, s[40:43], s52 offen offset:1024 nt lds
    buffer_load_dwordx4 v12, s[40:43], s52 offen offset:2048 nt lds
    buffer_load_dwordx4 v13, s[40:43], s52 offen offset:3072 nt lds
    s_add_u32 m0, s53, 81920
    s_nop 0
    buffer_load_dwordx4 v14, s[44:47], s52 offen offset:0 nt lds
    buffer_load_dwordx4 v15, s[44:47], s52 offen offset:1024 nt lds
    buffer_load_dwordx4 v16, s[44:47], s52 offen offset:2048 nt lds
    buffer_load_dwordx4 v17, s[44:47], s52 offen offset:3072 nt lds
    s_waitcnt vmcnt(24)
    s_barrier
    s_mov_b32 s52, 147456
    s_add_u32 m0, s53, 98304
    s_nop 0
    buffer_load_dwordx4 v10, s[40:43], s52 offen offset:0 nt lds
    buffer_load_dwordx4 v11, s[40:43], s52 offen offset:1024 nt lds
    buffer_load_dwordx4 v12, s[40:43], s52 offen offset:2048 nt lds
    buffer_load_dwordx4 v13, s[40:43], s52 offen offset:3072 nt lds
    s_add_u32 m0, s53, 114688
    s_nop 0
    buffer_load_dwordx4 v14, s[44:47], s52 offen offset:0 nt lds
    buffer_load_dwordx4 v15, s[44:47], s52 offen offset:1024 nt lds
    buffer_load_dwordx4 v16, s[44:47], s52 offen offset:2048 nt lds
    buffer_load_dwordx4 v17, s[44:47], s52 offen offset:3072 nt lds
    s_waitcnt vmcnt(24)
    s_barrier
    s_mov_b32 s52, 163840
    s_add_u32 m0, s53, 131072
    s_nop 0
    buffer_load_dwordx4 v10, s[40:43], s52 offen offset:0 nt lds
    buffer_load_dwordx4 v11, s[40:43], s52 offen offset:1024 nt lds
    buffer_load_dwordx4 v12, s[40:43], s52 offen offset:2048 nt lds
    buffer_load_dwordx4 v13, s[40:43], s52 offen offset:3072 nt lds
    s_add_u32 m0, s53, 147456
    s_nop 0
    buffer_load_dwordx4 v14, s[44:47], s52 offen offset:0 nt lds
    buffer_load_dwordx4 v15, s[44:47], s52 offen offset:1024 nt lds
    buffer_load_dwordx4 v16, s[44:47], s52 offen offset:2048 nt lds
    buffer_load_dwordx4 v17, s[44:47], s52 offen offset:3072 nt lds
    s_waitcnt vmcnt(24)
    s_barrier
    s_mov_b32 s52, 180224
    s_add_u32 m0, s53, 0
    s_nop 0
    buffer_load_dwordx4 v10, s[40:43], s52 offen offset:0 nt lds
    buffer_load_dwordx4 v11, s[40:43], s52 offen offset:1024 nt lds
    buffer_load_dwordx4 v12, s[40:43], s52 offen offset:2048 nt lds
    buffer_load_dwordx4 v13, s[40:43], s52 offen offset:3072 nt lds
    s_add_u32 m0, s53, 16384
    s_nop 0
    buffer_load_dwordx4 v14, s[44:47], s52 offen offset:0 nt lds
    buffer_load_dwordx4 v15, s[44:47], s52 offen offset:1024 nt lds
    buffer_load_dwordx4 v16, s[44:47], s52 offen offset:2048 nt lds
    buffer_load_dwordx4 v17, s[44:47], s52 offen offset:3072 nt lds
    s_waitcnt vmcnt(24)
    s_barrier
    s_mov_b32 s52, 196608
    s_add_u32 m0, s53, 32768
    s_nop 0
    buffer_load_dwordx4 v10, s[40:43], s52 offen offset:0 nt lds
    buffer_load_dwordx4 v11, s[40:43], s52 offen offset:1024 nt lds
    buffer_load_dwordx4 v12, s[40:43], s52 offen offset:2048 nt lds
    buffer_load_dwordx4 v13, s[40:43], s52 offen offset:3072 nt lds
    s_add_u32 m0, s53, 49152
    s_nop 0
    buffer_load_dwordx4 v14, s[44:47], s52 offen offset:0 nt lds
    buffer_load_dwordx4 v15, s[44:47], s52 offen offset:1024 nt lds
    buffer_load_dwordx4 v16, s[44:47], s52 offen offset:2048 nt lds
    buffer_load_dwordx4 v17, s[44:47], s52 offen offset:3072 nt lds
    s_waitcnt vmcnt(24)
    s_barrier
    s_mov_b32 s52, 212992
    s_add_u32 m0, s53, 65536
    s_nop 0
    buffer_load_dwordx4 v10, s[40:43], s52 offen offset:0 nt lds
    buffer_load_dwordx4 v11, s[40:43], s52 offen offset:1024 nt lds
    buffer_load_dwordx4 v12, s[40:43], s52 offen offset:2048 nt lds
    buffer_load_dwordx4 v13, s[40:43], s52 offen offset:3072 nt lds
    s_add_u32 m0, s53, 81920
    s_nop 0
    buffer_load_dwordx4 v14, s[44:47], s52 offen offset:0 nt lds
    buffer_load_dwordx4 v15, s[44:47], s52 offen offset:1024 nt lds
    buffer_load_dwordx4 v16, s[44:47], s52 offen offset:2048 nt lds
    buffer_load_dwordx4 v17, s[44:47], s52 offen offset:3072 nt lds
    s_waitcnt vmcnt(24)
    s_barrier
    s_mov_b32 s52, 229376
    s_add_u32 m0, s53, 98304
    s_nop 0
    buffer_load_dwordx4 v10, s[40:43], s52 offen offset:0 nt lds
    buffer_load_dwordx4 v11, s[40:43], s52 offen offset:1024 nt lds
    buffer_load_dwordx4 v12, s[40:43], s52 offen offset:2048 nt lds
    buffer_load_dwordx4 v13, s[40:43], s52 offen offset:3072 nt lds
    s_add_u32 m0, s53, 114688
    s_nop 0
    buffer_load_dwordx4 v14, s[44:47], s52 offen offset:0 nt lds
    buffer_load_dwordx4 v15, s[44:47], s52 offen offset:1024 nt lds
    buffer_load_dwordx4 v16, s[44:47], s52 offen offset:2048 nt lds
    buffer_load_dwordx4 v17, s[44:47], s52 offen offset:3072 nt lds
    s_waitcnt vmcnt(24)
    s_barrier
    s_mov_b32 s52, 245760
    s_add_u32 m0, s53, 131072
    s_nop 0
    buffer_load_dwordx4 v10, s[40:43], s52 offen offset:0 nt lds
    buffer_load_dwordx4 v11, s[40:43], s52 offen offset:1024 nt lds
    buffer_load_dwordx4 v12, s[40:43], s52 offen offset:2048 nt lds
    buffer_load_dwordx4 v13, s[40:43], s52 offen offset:3072 nt lds
    s_add_u32 m0, s53, 147456
    s_nop 0
    buffer_load_dwordx4 v14, s[44:47], s52 offen offset:0 nt lds
    buffer_load_dwordx4 v15, s[44:47], s52 offen offset:1024 nt lds
    buffer_load_dwordx4 v16, s[44:47], s52 offen offset:2048 nt lds
    buffer_load_dwordx4 v17, s[44:47], s52 offen offset:3072 nt lds
    s_waitcnt vmcnt(24)
    s_barrier
    s_mov_b32 s52, 262144
    s_add_u32 m0, s53, 0
    s_nop 0
    buffer_load_dwordx4 v10, s[40:43], s52 offen offset:0 nt lds
    buffer_load_dwordx4 v11, s[40:43], s52 offen offset:1024 nt lds
    buffer_load_dwordx4 v12, s[40:43], s52 offen offset:2048 nt lds
    buffer_load_dwordx4 v13, s[40:43], s52 offen offset:3072 nt lds
    s_add_u32 m0, s53, 16384
    s_nop 0
    buffer_load_dwordx4 v14, s[44:47], s52 offen offset:0 nt lds
    buffer_load_dwordx4 v15, s[44:47], s52 offen offset:1024 nt lds
    buffer_load_dwordx4 v16, s[44:47], s52 offen offset:2048 nt lds
    buffer_load_dwordx4 v17, s[44:47], s52 offen offset:3072 nt lds
    s_waitcnt vmcnt(24)
    s_barrier
    s_mov_b32 s52, 278528
    s_add_u32 m0, s53, 32768
    s_nop 0
    buffer_load_dwordx4 v10, s[40:43], s52 offen offset:0 nt lds
    buffer_load_dwordx4 v11, s[40:43], s52 offen offset:1024 nt lds
    buffer_load_dwordx4 v12, s[40:43], s52 offen offset:2048 nt lds
    buffer_load_dwordx4 v13, s[40:43], s52 offen offset:3072 nt lds
    s_add_u32 m0, s53, 49152
    s_nop 0
    buffer_load_dwordx4 v14, s[44:47], s52 offen offset:0 nt lds
    buffer_load_dwordx4 v15, s[44:47], s52 offen offset:1024 nt lds
    buffer_load_dwordx4 v16, s[44:47], s52 offen offset:2048 nt lds
    buffer_load_dwordx4 v17, s[44:47], s52 offen offset:3072 nt lds
    s_waitcnt vmcnt(24)
    s_barrier
    s_mov_b32 s52, 294912
    s_add_u32 m0, s53, 65536
    s_nop 0
    buffer_load_dwordx4 v10, s[40:43], s52 offen offset:0 nt lds
    buffer_load_dwordx4 v11, s[40:43], s52 offen offset:1024 nt lds
    buffer_load_dwordx4 v12, s[40:43], s52 offen offset:2048 nt lds
    buffer_load_dwordx4 v13, s[40:43], s52 offen offset:3072 nt lds
    s_add_u32 m0, s53, 81920
    s_nop 0
    buffer_load_dwordx4 v14, s[44:47], s52 offen offset:0 nt lds
    buffer_load_dwordx4 v15, s[44:47], s52 offen offset:1024 nt lds
    buffer_load_dwordx4 v16, s[44:47], s52 offen offset:2048 nt lds
    buffer_load_dwordx4 v17, s[44:47], s52 offen offset:3072 nt lds
    s_waitcnt vmcnt(24)
    s_barrier
    s_mov_b32 s52, 311296
    s_add_u32 m0, s53, 98304
    s_nop 0
    buffer_load_dwordx4 v10, s[40:43], s52 offen offset:0 nt lds
    buffer_load_dwordx4 v11, s[40:43], s52 offen offset:1024 nt lds
    buffer_load_dwordx4 v12, s[40:43], s52 offen offset:2048 nt lds
    buffer_load_dwordx4 v13, s[40:43], s52 offen offset:3072 nt lds
    s_add_u32 m0, s53, 114688
    s_nop 0
    buffer_load_dwordx4 v14, s[44:47], s52 offen offset:0 nt lds
    buffer_load_dwordx4 v15, s[44:47], s52 offen offset:1024 nt lds
    buffer_load_dwordx4 v16, s[44:47], s52 offen offset:2048 nt lds
    buffer_load_dwordx4 v17, s[44:47], s52 offen offset:3072 nt lds
    s_waitcnt vmcnt(24)
    s_barrier
    s_mov_b32 s52, 327680
    s_add_u32 m0, s53, 131072
    s_nop 0
    buffer_load_dwordx4 v10, s[40:43], s52 offen offset:0 nt lds
    buffer_load_dwordx4 v11, s[40:43], s52 offen offset:1024 nt lds
    buffer_load_dwordx4 v12, s[40:43], s52 offen offset:2048 nt lds
    buffer_load_dwordx4 v13, s[40:43], s52 offen offset:3072 nt lds
    s_add_u32 m0, s53, 147456
    s_nop 0
    buffer_load_dwordx4 v14, s[44:47], s52 offen offset:0 nt lds
    buffer_load_dwordx4 v15, s[44:47], s52 offen offset:1024 nt lds
    buffer_load_dwordx4 v16, s[44:47], s52 offen offset:2048 nt lds
    buffer_load_dwordx4 v17, s[44:47], s52 offen offset:3072 nt lds
    s_waitcnt vmcnt(24)
    s_barrier
    s_mov_b32 s52, 344064
    s_add_u32 m0, s53, 0
    s_nop 0
    buffer_load_dwordx4 v10, s[40:43], s52 offen offset:0 nt lds
    buffer_load_dwordx4 v11, s[40:43], s52 offen offset:1024 nt lds
    buffer_load_dwordx4 v12, s[40:43], s52 offen offset:2048 nt lds
    buffer_load_dwordx4 v13, s[40:43], s52 offen offset:3072 nt lds
    s_add_u32 m0, s53, 16384
    s_nop 0
    buffer_load_dwordx4 v14, s[44:47], s52 offen offset:0 nt lds
    buffer_load_dwordx4 v15, s[44:47], s52 offen offset:1024 nt lds
    buffer_load_dwordx4 v16, s[44:47], s52 offen offset:2048 nt lds
    buffer_load_dwordx4 v17, s[44:47], s52 offen offset:3072 nt lds
    s_waitcnt vmcnt(24)
    s_barrier
    s_mov_b32 s52, 360448
    s_add_u32 m0, s53, 32768
    s_nop 0
    buffer_load_dwordx4 v10, s[40:43], s52 offen offset:0 nt lds
    buffer_load_dwordx4 v11, s[40:43], s52 offen offset:1024 nt lds
    buffer_load_dwordx4 v12, s[40:43], s52 offen offset:2048 nt lds
    buffer_load_dwordx4 v13, s[40:43], s52 offen offset:3072 nt lds
    s_add_u32 m0, s53, 49152
    s_nop 0
    buffer_load_dwordx4 v14, s[44:47], s52 offen offset:0 nt lds
    buffer_load_dwordx4 v15, s[44:47], s52 offen offset:1024 nt lds
    buffer_load_dwordx4 v16, s[44:47], s52 offen offset:2048 nt lds
    buffer_load_dwordx4 v17, s[44:47], s52 offen offset:3072 nt lds
    s_waitcnt vmcnt(24)
    s_barrier
    s_mov_b32 s52, 376832
    s_add_u32 m0, s53, 65536
    s_nop 0
    buffer_load_dwordx4 v10, s[40:43], s52 offen offset:0 nt lds
    buffer_load_dwordx4 v11, s[40:43], s52 offen offset:1024 nt lds
    buffer_load_dwordx4 v12, s[40:43], s52 offen offset:2048 nt lds
    buffer_load_dwordx4 v13, s[40:43], s52 offen offset:3072 nt lds
    s_add_u32 m0, s53, 81920
    s_nop 0
    buffer_load_dwordx4 v14, s[44:47], s52 offen offset:0 nt lds
    buffer_load_dwordx4 v15, s[44:47], s52 offen offset:1024 nt lds
    buffer_load_dwordx4 v16, s[44:47], s52 offen offset:2048 nt lds
    buffer_load_dwordx4 v17, s[44:47], s52 offen offset:3072 nt lds
    s_waitcnt vmcnt(24)
    s_barrier
    s_mov_b32 s52, 393216
    s_add_u32 m0, s53, 98304
    s_nop 0
    buffer_load_dwordx4 v10, s[40:43], s52 offen offset:0 nt lds
    buffer_load_dwordx4 v11, s[40:43], s52 offen offset:1024 nt lds
    buffer_load_dwordx4 v12, s[40:43], s52 offen offset:2048 nt lds
    buffer_load_dwordx4 v13, s[40:43], s52 offen offset:3072 nt lds
    s_add_u32 m0, s53, 114688
    s_nop 0
    buffer_load_dwordx4 v14, s[44:47], s52 offen offset:0 nt lds
    buffer_load_dwordx4 v15, s[44:47], s52 offen offset:1024 nt lds
    buffer_load_dwordx4 v16, s[44:47], s52 offen offset:2048 nt lds
    buffer_load_dwordx4 v17, s[44:47], s52 offen offset:3072 nt lds
    s_waitcnt vmcnt(24)
    s_barrier
    s_mov_b32 s52, 409600
    s_add_u32 m0, s53, 131072
    s_nop 0
    buffer_load_dwordx4 v10, s[40:43], s52 offen offset:0 nt lds
    buffer_load_dwordx4 v11, s[40:43], s52 offen offset:1024 nt lds
    buffer_load_dwordx4 v12, s[40:43], s52 offen offset:2048 nt lds
    buffer_load_dwordx4 v13, s[40:43], s52 offen offset:3072 nt lds
    s_add_u32 m0, s53, 147456
    s_nop 0
    buffer_load_dwordx4 v14, s[44:47], s52 offen offset:0 nt lds
    buffer_load_dwordx4 v15, s[44:47], s52 offen offset:1024 nt lds
    buffer_load_dwordx4 v16, s[44:47], s52 offen offset:2048 nt lds
    buffer_load_dwordx4 v17, s[44:47], s52 offen offset:3072 nt lds
    s_waitcnt vmcnt(24)
    s_barrier
    s_mov_b32 s52, 425984
    s_add_u32 m0, s53, 0
    s_nop 0
    buffer_load_dwordx4 v10, s[40:43], s52 offen offset:0 nt lds
    buffer_load_dwordx4 v11, s[40:43], s52 offen offset:1024 nt lds
    buffer_load_dwordx4 v12, s[40:43], s52 offen offset:2048 nt lds
    buffer_load_dwordx4 v13, s[40:43], s52 offen offset:3072 nt lds
    s_add_u32 m0, s53, 16384
    s_nop 0
    buffer_load_dwordx4 v14, s[44:47], s52 offen offset:0 nt lds
    buffer_load_dwordx4 v15, s[44:47], s52 offen offset:1024 nt lds
    buffer_load_dwordx4 v16, s[44:47], s52 offen offset:2048 nt lds
    buffer_load_dwordx4 v17, s[44:47], s52 offen offset:3072 nt lds
    s_waitcnt vmcnt(24)
    s_barrier
    s_mov_b32 s52, 442368
    s_add_u32 m0, s53, 32768
    s_nop 0
    buffer_load_dwordx4 v10, s[40:43], s52 offen offset:0 nt lds
    buffer_load_dwordx4 v11, s[40:43], s52 offen offset:1024 nt lds
    buffer_load_dwordx4 v12, s[40:43], s52 offen offset:2048 nt lds
    buffer_load_dwordx4 v13, s[40:43], s52 offen offset:3072 nt lds
    s_add_u32 m0, s53, 49152
    s_nop 0
    buffer_load_dwordx4 v14, s[44:47], s52 offen offset:0 nt lds
    buffer_load_dwordx4 v15, s[44:47], s52 offen offset:1024 nt lds
    buffer_load_dwordx4 v16, s[44:47], s52 offen offset:2048 nt lds
    buffer_load_dwordx4 v17, s[44:47], s52 offen offset:3072 nt lds
    s_waitcnt vmcnt(24)
    s_barrier
    s_mov_b32 s52, 458752
    s_add_u32 m0, s53, 65536
    s_nop 0
    buffer_load_dwordx4 v10, s[40:43], s52 offen offset:0 nt lds
    buffer_load_dwordx4 v11, s[40:43], s52 offen offset:1024 nt lds
    buffer_load_dwordx4 v12, s[40:43], s52 offen offset:2048 nt lds
    buffer_load_dwordx4 v13, s[40:43], s52 offen offset:3072 nt lds
    s_add_u32 m0, s53, 81920
    s_nop 0
    buffer_load_dwordx4 v14, s[44:47], s52 offen offset:0 nt lds
    buffer_load_dwordx4 v15, s[44:47], s52 offen offset:1024 nt lds
    buffer_load_dwordx4 v16, s[44:47], s52 offen offset:2048 nt lds
    buffer_load_dwordx4 v17, s[44:47], s52 offen offset:3072 nt lds
    s_waitcnt vmcnt(24)
    s_barrier
    s_mov_b32 s52, 475136
    s_add_u32 m0, s53, 98304
    s_nop 0
    buffer_load_dwordx4 v10, s[40:43], s52 offen offset:0 nt lds
    buffer_load_dwordx4 v11, s[40:43], s52 offen offset:1024 nt lds
    buffer_load_dwordx4 v12, s[40:43], s52 offen offset:2048 nt lds
    buffer_load_dwordx4 v13, s[40:43], s52 offen offset:3072 nt lds
    s_add_u32 m0, s53, 114688
    s_nop 0
    buffer_load_dwordx4 v14, s[44:47], s52 offen offset:0 nt lds
    buffer_load_dwordx4 v15, s[44:47], s52 offen offset:1024 nt lds
    buffer_load_dwordx4 v16, s[44:47], s52 offen offset:2048 nt lds
    buffer_load_dwordx4 v17, s[44:47], s52 offen offset:3072 nt lds
    s_waitcnt vmcnt(24)
    s_barrier
    s_mov_b32 s52, 491520
    s_add_u32 m0, s53, 131072
    s_nop 0
    buffer_load_dwordx4 v10, s[40:43], s52 offen offset:0 nt lds
    buffer_load_dwordx4 v11, s[40:43], s52 offen offset:1024 nt lds
    buffer_load_dwordx4 v12, s[40:43], s52 offen offset:2048 nt lds
    buffer_load_dwordx4 v13, s[40:43], s52 offen offset:3072 nt lds
    s_add_u32 m0, s53, 147456
    s_nop 0
    buffer_load_dwordx4 v14, s[44:47], s52 offen offset:0 nt lds
    buffer_load_dwordx4 v15, s[44:47], s52 offen offset:1024 nt lds
    buffer_load_dwordx4 v16, s[44:47], s52 offen offset:2048 nt lds
    buffer_load_dwordx4 v17, s[44:47], s52 offen offset:3072 nt lds
    s_waitcnt vmcnt(24)
    s_barrier
    s_mov_b32 s52, 507904
    s_add_u32 m0, s53, 0
    s_nop 0
    buffer_load_dwordx4 v10, s[40:43], s52 offen offset:0 nt lds
    buffer_load_dwordx4 v11, s[40:43], s52 offen offset:1024 nt lds
    buffer_load_dwordx4 v12, s[40:43], s52 offen offset:2048 nt lds
    buffer_load_dwordx4 v13, s[40:43], s52 offen offset:3072 nt lds
    s_add_u32 m0, s53, 16384
    s_nop 0
    buffer_load_dwordx4 v14, s[44:47], s52 offen offset:0 nt lds
    buffer_load_dwordx4 v15, s[44:47], s52 offen offset:1024 nt lds
    buffer_load_dwordx4 v16, s[44:47], s52 offen offset:2048 nt lds
    buffer_load_dwordx4 v17, s[44:47], s52 offen offset:3072 nt lds
    s_waitcnt vmcnt(24)
    s_barrier
    s_mul_i32 s52, s96, 28672
    s_add_u32 s96, s96, 1
    s_and_b32 s96, s96, 15
    s_add_u32 m0, s63, 32768
    s_nop 0
    buffer_load_dwordx4 v18, s[48:51], s52 offen lds
    s_add_u32 m0, s63, 33792
    s_nop 0
    buffer_load_dwordx4 v19, s[48:51], s52 offen lds
    s_add_u32 m0, s63, 34816
    s_nop 0
    buffer_load_dwordx4 v20, s[48:51], s52 offen lds
    s_add_u32 m0, s63, 35840
    s_nop 0
    buffer_load_dwordx4 v21, s[48:51], s52 offen lds
    s_add_u32 m0, s63, 36864
    s_nop 0
    buffer_load_dwordx4 v22, s[48:51], s52 offen lds
    s_add_u32 m0, s63, 37888
    s_nop 0
    buffer_load_dwordx4 v23, s[48:51], s52 offen lds
    s_add_u32 m0, s63, 38912
    s_nop 0
    buffer_load_dwordx4 v24, s[48:51], s52 offen lds
    s_waitcnt vmcnt(23)
    s_barrier
    s_mul_i32 s52, s96, 28672
    s_add_u32 s96, s96, 1
    s_and_b32 s96, s96, 15
    s_add_u32 m0, s63, 65536
    s_nop 0
    buffer_load_dwordx4 v18, s[48:51], s52 offen lds
    s_add_u32 m0, s63, 66560
    s_nop 0
    buffer_load_dwordx4 v19, s[48:51], s52 offen lds
    s_add_u32 m0, s63, 67584
    s_nop 0
    buffer_load_dwordx4 v20, s[48:51], s52 offen lds
    s_add_u32 m0, s63, 68608
    s_nop 0
    buffer_load_dwordx4 v21, s[48:51], s52 offen lds
    s_add_u32 m0, s63, 69632
    s_nop 0
    buffer_load_dwordx4 v22, s[48:51], s52 offen lds
    s_add_u32 m0, s63, 70656
    s_nop 0
    buffer_load_dwordx4 v23, s[48:51], s52 offen lds
    s_add_u32 m0, s63, 71680
    s_nop 0
    buffer_load_dwordx4 v24, s[48:51], s52 offen lds
    s_waitcnt vmcnt(22)
    s_barrier
    s_waitcnt vmcnt(14)
    s_barrier
    s_waitcnt vmcnt(7)
    s_barrier
    s_mul_i32 s52, s96, 28672
    s_add_u32 s96, s96, 1
    s_and_b32 s96, s96, 15
    s_add_u32 m0, s63, 0
    s_nop 0
    buffer_load_dwordx4 v18, s[48:51], s52 offen lds
    s_add_u32 m0, s63, 1024
    s_nop 0
    buffer_load_dwordx4 v19, s[48:51], s52 offen lds
    s_add_u32 m0, s63, 2048
    s_nop 0
    buffer_load_dwordx4 v20, s[48:51], s52 offen lds
    s_add_u32 m0, s63, 3072
    s_nop 0
    buffer_load_dwordx4 v21, s[48:51], s52 offen lds
    s_add_u32 m0, s63, 4096
    s_nop 0
    buffer_load_dwordx4 v22, s[48:51], s52 offen lds
    s_add_u32 m0, s63, 5120
    s_nop 0
    buffer_load_dwordx4 v23, s[48:51], s52 offen lds
    s_add_u32 m0, s63, 6144
    s_nop 0
    buffer_load_dwordx4 v24, s[48:51], s52 offen lds
    s_waitcnt vmcnt(7)
    s_barrier
    s_mul_i32 s52, s96, 28672
    s_add_u32 s96, s96, 1
    s_and_b32 s96, s96, 15
    s_add_u32 m0, s63, 32768
    s_nop 0
    buffer_load_dwordx4 v18, s[48:51], s52 offen lds
    s_add_u32 m0, s63, 33792
    s_nop 0
    buffer_load_dwordx4 v19, s[48:51], s52 offen lds
    s_add_u32 m0, s63, 34816
    s_nop 0
    buffer_load_dwordx4 v20, s[48:51], s52 offen lds
    s_add_u32 m0, s63, 35840
    s_nop 0
    buffer_load_dwordx4 v21, s[48:51], s52 offen lds
    s_add_u32 m0, s63, 36864
    s_nop 0
    buffer_load_dwordx4 v22, s[48:51], s52 offen lds
    s_add_u32 m0, s63, 37888
    s_nop 0
    buffer_load_dwordx4 v23, s[48:51], s52 offen lds
    s_add_u32 m0, s63, 38912
    s_nop 0
    buffer_load_dwordx4 v24, s[48:51], s52 offen lds
    s_waitcnt vmcnt(7)
    s_barrier
    s_mul_i32 s52, s96, 28672
    s_add_u32 s96, s96, 1
    s_and_b32 s96, s96, 15
    s_add_u32 m0, s63, 65536
    s_nop 0
    buffer_load_dwordx4 v18, s[48:51], s52 offen lds
    s_add_u32 m0, s63, 66560
    s_nop 0
    buffer_load_dwordx4 v19, s[48:51], s52 offen lds
    s_add_u32 m0, s63, 67584
    s_nop 0
    buffer_load_dwordx4 v20, s[48:51], s52 offen lds
    s_add_u32 m0, s63, 68608
    s_nop 0
    buffer_load_dwordx4 v21, s[48:51], s52 offen lds
    s_add_u32 m0, s63, 69632
    s_nop 0
    buffer_load_dwordx4 v22, s[48:51], s52 offen lds
    s_add_u32 m0, s63, 70656
    s_nop 0
    buffer_load_dwordx4 v23, s[48:51], s52 offen lds
    s_add_u32 m0, s63, 71680
    s_nop 0
    buffer_load_dwordx4 v24, s[48:51], s52 offen lds
    s_waitcnt vmcnt(7)
    s_barrier
    s_mul_i32 s52, s96, 28672
    s_add_u32 s96, s96, 1
    s_and_b32 s96, s96, 15
    s_add_u32 m0, s63, 0
    s_nop 0
    buffer_load_dwordx4 v18, s[48:51], s52 offen lds
    s_add_u32 m0, s63, 1024
    s_nop 0
    buffer_load_dwordx4 v19, s[48:51], s52 offen lds
    s_add_u32 m0, s63, 2048
    s_nop 0
    buffer_load_dwordx4 v20, s[48:51], s52 offen lds
    s_add_u32 m0, s63, 3072
    s_nop 0
    buffer_load_dwordx4 v21, s[48:51], s52 offen lds
    s_add_u32 m0, s63, 4096
    s_nop 0
    buffer_load_dwordx4 v22, s[48:51], s52 offen lds
    s_add_u32 m0, s63, 5120
    s_nop 0
    buffer_load_dwordx4 v23, s[48:51], s52 offen lds
    s_add_u32 m0, s63, 6144
    s_nop 0
    buffer_load_dwordx4 v24, s[48:51], s52 offen lds
    s_waitcnt vmcnt(7)
    s_barrier
    s_mul_i32 s52, s96, 28672
    s_add_u32 s96, s96, 1
    s_and_b32 s96, s96, 15
    s_add_u32 m0, s63, 32768
    s_nop 0
    buffer_load_dwordx4 v18, s[48:51], s52 offen lds
    s_add_u32 m0, s63, 33792
    s_nop 0
    buffer_load_dwordx4 v19, s[48:51], s52 offen lds
    s_add_u32 m0, s63, 34816
    s_nop 0
    buffer_load_dwordx4 v20, s[48:51], s52 offen lds
    s_add_u32 m0, s63, 35840
    s_nop 0
    buffer_load_dwordx4 v21, s[48:51], s52 offen lds
    s_add_u32 m0, s63, 36864
    s_nop 0
    buffer_load_dwordx4 v22, s[48:51], s52 offen lds
    s_add_u32 m0, s63, 37888
    s_nop 0
    buffer_load_dwordx4 v23, s[48:51], s52 offen lds
    s_add_u32 m0, s63, 38912
    s_nop 0
    buffer_load_dwordx4 v24, s[48:51], s52 offen lds
    s_waitcnt vmcnt(7)
    s_barrier
    s_mul_i32 s52, s96, 28672
    s_add_u32 s96, s96, 1
    s_and_b32 s96, s96, 15
    s_add_u32 m0, s63, 65536
    s_nop 0
    buffer_load_dwordx4 v18, s[48:51], s52 offen lds
    s_add_u32 m0, s63, 66560
    s_nop 0
    buffer_load_dwordx4 v19, s[48:51], s52 offen lds
    s_add_u32 m0, s63, 67584
    s_nop 0
    buffer_load_dwordx4 v20, s[48:51], s52 offen lds
    s_add_u32 m0, s63, 68608
    s_nop 0
    buffer_load_dwordx4 v21, s[48:51], s52 offen lds
    s_add_u32 m0, s63, 69632
    s_nop 0
    buffer_load_dwordx4 v22, s[48:51], s52 offen lds
    s_add_u32 m0, s63, 70656
    s_nop 0
    buffer_load_dwordx4 v23, s[48:51], s52 offen lds
    s_add_u32 m0, s63, 71680
    s_nop 0
    buffer_load_dwordx4 v24, s[48:51], s52 offen lds
    s_waitcnt vmcnt(7)
    s_barrier
    s_mul_i32 s52, s96, 28672
    s_add_u32 s96, s96, 1
    s_and_b32 s96, s96, 15
    s_add_u32 m0, s63, 0
    s_nop 0
    buffer_load_dwordx4 v18, s[48:51], s52 offen lds
    s_add_u32 m0, s63, 1024
    s_nop 0
    buffer_load_dwordx4 v19, s[48:51], s52 offen lds
    s_add_u32 m0, s63, 2048
    s_nop 0
    buffer_load_dwordx4 v20, s[48:51], s52 offen lds
    s_add_u32 m0, s63, 3072
    s_nop 0
    buffer_load_dwordx4 v21, s[48:51], s52 offen lds
    s_add_u32 m0, s63, 4096
    s_nop 0
    buffer_load_dwordx4 v22, s[48:51], s52 offen lds
    s_add_u32 m0, s63, 5120
    s_nop 0
    buffer_load_dwordx4 v23, s[48:51], s52 offen lds
    s_add_u32 m0, s63, 6144
    s_nop 0
    buffer_load_dwordx4 v24, s[48:51], s52 offen lds
    s_waitcnt vmcnt(7)
    s_barrier
    s_mul_i32 s52, s96, 28672
    s_add_u32 s96, s96, 1
    s_and_b32 s96, s96, 15
    s_add_u32 m0, s63, 32768
    s_nop 0
    buffer_load_dwordx4 v18, s[48:51], s52 offen lds
    s_add_u32 m0, s63, 33792
    s_nop 0
    buffer_load_dwordx4 v19, s[48:51], s52 offen lds
    s_add_u32 m0, s63, 34816
    s_nop 0
    buffer_load_dwordx4 v20, s[48:51], s52 offen lds
    s_add_u32 m0, s63, 35840
    s_nop 0
    buffer_load_dwordx4 v21, s[48:51], s52 offen lds
    s_add_u32 m0, s63, 36864
    s_nop 0
    buffer_load_dwordx4 v22, s[48:51], s52 offen lds
    s_add_u32 m0, s63, 37888
    s_nop 0
    buffer_load_dwordx4 v23, s[48:51], s52 offen lds
    s_add_u32 m0, s63, 38912
    s_nop 0
    buffer_load_dwordx4 v24, s[48:51], s52 offen lds
    s_waitcnt vmcnt(7)
    s_barrier
    s_mul_i32 s52, s96, 28672
    s_add_u32 s96, s96, 1
    s_and_b32 s96, s96, 15
    s_add_u32 m0, s63, 65536
    s_nop 0
    buffer_load_dwordx4 v18, s[48:51], s52 offen lds
    s_add_u32 m0, s63, 66560
    s_nop 0
    buffer_load_dwordx4 v19, s[48:51], s52 offen lds
    s_add_u32 m0, s63, 67584
    s_nop 0
    buffer_load_dwordx4 v20, s[48:51], s52 offen lds
    s_add_u32 m0, s63, 68608
    s_nop 0
    buffer_load_dwordx4 v21, s[48:51], s52 offen lds
    s_add_u32 m0, s63, 69632
    s_nop 0
    buffer_load_dwordx4 v22, s[48:51], s52 offen lds
    s_add_u32 m0, s63, 70656
    s_nop 0
    buffer_load_dwordx4 v23, s[48:51], s52 offen lds
    s_add_u32 m0, s63, 71680
    s_nop 0
    buffer_load_dwordx4 v24, s[48:51], s52 offen lds
    s_waitcnt vmcnt(7)
    s_barrier
    s_mul_i32 s52, s96, 28672
    s_add_u32 s96, s96, 1
    s_and_b32 s96, s96, 15
    s_add_u32 m0, s63, 0
    s_nop 0
    buffer_load_dwordx4 v18, s[48:51], s52 offen lds
    s_add_u32 m0, s63, 1024
    s_nop 0
    buffer_load_dwordx4 v19, s[48:51], s52 offen lds
    s_add_u32 m0, s63, 2048
    s_nop 0
    buffer_load_dwordx4 v20, s[48:51], s52 offen lds
    s_add_u32 m0, s63, 3072
    s_nop 0
    buffer_load_dwordx4 v21, s[48:51], s52 offen lds
    s_add_u32 m0, s63, 4096
    s_nop 0
    buffer_load_dwordx4 v22, s[48:51], s52 offen lds
    s_add_u32 m0, s63, 5120
    s_nop 0
    buffer_load_dwordx4 v23, s[48:51], s52 offen lds
    s_add_u32 m0, s63, 6144
    s_nop 0
    buffer_load_dwordx4 v24, s[48:51], s52 offen lds
    s_waitcnt vmcnt(7)
    s_barrier
    s_mul_i32 s52, s96, 28672
    s_add_u32 s96, s96, 1
    s_and_b32 s96, s96, 15
    s_add_u32 m0, s63, 32768
    s_nop 0
    buffer_load_dwordx4 v18, s[48:51], s52 offen lds
    s_add_u32 m0, s63, 33792
    s_nop 0
    buffer_load_dwordx4 v19, s[48:51], s52 offen lds
    s_add_u32 m0, s63, 34816
    s_nop 0
    buffer_load_dwordx4 v20, s[48:51], s52 offen lds
    s_add_u32 m0, s63, 35840
    s_nop 0
    buffer_load_dwordx4 v21, s[48:51], s52 offen lds
    s_add_u32 m0, s63, 36864
    s_nop 0
    buffer_load_dwordx4 v22, s[48:51], s52 offen lds
    s_add_u32 m0, s63, 37888
    s_nop 0
    buffer_load_dwordx4 v23, s[48:51], s52 offen lds
    s_add_u32 m0, s63, 38912
    s_nop 0
    buffer_load_dwordx4 v24, s[48:51], s52 offen lds
    s_waitcnt vmcnt(7)
    s_barrier
    s_mul_i32 s52, s96, 28672
    s_add_u32 s96, s96, 1
    s_and_b32 s96, s96, 15
    s_add_u32 m0, s63, 65536
    s_nop 0
    buffer_load_dwordx4 v18, s[48:51], s52 offen lds
    s_add_u32 m0, s63, 66560
    s_nop 0
    buffer_load_dwordx4 v19, s[48:51], s52 offen lds
    s_add_u32 m0, s63, 67584
    s_nop 0
    buffer_load_dwordx4 v20, s[48:51], s52 offen lds
    s_add_u32 m0, s63, 68608
    s_nop 0
    buffer_load_dwordx4 v21, s[48:51], s52 offen lds
    s_add_u32 m0, s63, 69632
    s_nop 0
    buffer_load_dwordx4 v22, s[48:51], s52 offen lds
    s_add_u32 m0, s63, 70656
    s_nop 0
    buffer_load_dwordx4 v23, s[48:51], s52 offen lds
    s_add_u32 m0, s63, 71680
    s_nop 0
    buffer_load_dwordx4 v24, s[48:51], s52 offen lds
    s_waitcnt vmcnt(7)
    s_barrier
    s_mul_i32 s52, s96, 28672
    s_add_u32 s96, s96, 1
    s_and_b32 s96, s96, 15
    s_add_u32 m0, s63, 0
    s_nop 0
    buffer_load_dwordx4 v18, s[48:51], s52 offen lds
    s_add_u32 m0, s63, 1024
    s_nop 0
    buffer_load_dwordx4 v19, s[48:51], s52 offen lds
    s_add_u32 m0, s63, 2048
    s_nop 0
    buffer_load_dwordx4 v20, s[48:51], s52 offen lds
    s_add_u32 m0, s63, 3072
    s_nop 0
    buffer_load_dwordx4 v21, s[48:51], s52 offen lds
    s_add_u32 m0, s63, 4096
    s_nop 0
    buffer_load_dwordx4 v22, s[48:51], s52 offen lds
    s_add_u32 m0, s63, 5120
    s_nop 0
    buffer_load_dwordx4 v23, s[48:51], s52 offen lds
    s_add_u32 m0, s63, 6144
    s_nop 0
    buffer_load_dwordx4 v24, s[48:51], s52 offen lds
    s_waitcnt vmcnt(7)
    s_barrier
    s_mul_i32 s52, s96, 28672
    s_add_u32 s96, s96, 1
    s_and_b32 s96, s96, 15
    s_add_u32 m0, s63, 32768
    s_nop 0
    buffer_load_dwordx4 v18, s[48:51], s52 offen lds
    s_add_u32 m0, s63, 33792
    s_nop 0
    buffer_load_dwordx4 v19, s[48:51], s52 offen lds
    s_add_u32 m0, s63, 34816
    s_nop 0
    buffer_load_dwordx4 v20, s[48:51], s52 offen lds
    s_add_u32 m0, s63, 35840
    s_nop 0
    buffer_load_dwordx4 v21, s[48:51], s52 offen lds
    s_add_u32 m0, s63, 36864
    s_nop 0
    buffer_load_dwordx4 v22, s[48:51], s52 offen lds
    s_add_u32 m0, s63, 37888
    s_nop 0
    buffer_load_dwordx4 v23, s[48:51], s52 offen lds
    s_add_u32 m0, s63, 38912
    s_nop 0
    buffer_load_dwordx4 v24, s[48:51], s52 offen lds
    s_waitcnt vmcnt(7)
    s_barrier
    s_waitcnt vmcnt(0)
    s_barrier
L_exit:
    s_endpgm
.globl reduce_partials_kernel
.p2align 8
.type reduce_partials_kernel,@function
reduce_partials_kernel:
    s_cmp_ge_u32 s2, 448
    s_cbranch_scc1 R_exit
    s_load_dwordx2 s[4:5], s[0:1], 80
    s_load_dwordx2 s[6:7], s[0:1], 96
    s_mov_b32 s16, 306783379
    s_mul_hi_u32 s17, s2, s16
    s_mul_i32 s18, s17, 14
    s_sub_u32 s18, s2, s18
    v_lshrrev_b32 v1, 6, v0
    s_nop 0
    v_readfirstlane_b32 s19, v1
    s_lshl_b32 s18, s18, 2
    s_add_u32 s18, s18, s19
    s_mul_hi_u32 s19, s18, s16
    s_mul_i32 s20, s19, 14
    s_sub_u32 s20, s18, s20
    s_waitcnt lgkmcnt(0)
    s_mul_i32 s21, s17, 458752
    s_lshl_b32 s22, s18, 10
    s_add_u32 s21, s21, s22
    s_add_u32 s8, s6, s21
    s_addc_u32 s9, s7, 0
    s_mov_b32 s10, 402432
    s_mov_b32 s11, 0x00020000
    s_mov_b32 s12, s4
    s_mov_b32 s13, s5
    s_mov_b32 s14, 1835008
    s_mov_b32 s15, 0x00020000
    v_and_b32 v1, 63, v0
    v_lshlrev_b32 v2, 4, v1
    s_mov_b32 s23, 0
    buffer_load_dwordx4 v[8:11], v2, s[8:11], s23 offen
    s_mov_b32 s23, 57344
    buffer_load_dwordx4 v[12:15], v2, s[8:11], s23 offen
    s_mov_b32 s23, 114688
    buffer_load_dwordx4 v[16:19], v2, s[8:11], s23 offen
    s_mov_b32 s23, 172032
    buffer_load_dwordx4 v[20:23], v2, s[8:11], s23 offen
    s_mov_b32 s23, 229376
    buffer_load_dwordx4 v[24:27], v2, s[8:11], s23 offen
    s_mov_b32 s23, 286720
    buffer_load_dwordx4 v[28:31], v2, s[8:11], s23 offen
    s_mov_b32 s23, 344064
    buffer_load_dwordx4 v[32:35], v2, s[8:11], s23 offen
    s_mov_b32 s23, 401408
    buffer_load_dwordx4 v[36:39], v2, s[8:11], s23 offen
    s_and_b32 s24, s17, 15
    s_lshr_b32 s25, s17, 4
    s_lshl_b32 s24, s24, 6
    s_and_b32 s26, s19, 1
    s_lshl_b32 s26, s26, 5
    s_add_u32 s24, s24, s26
    s_and_b32 s26, s20, 1
    s_lshl_b32 s26, s26, 4
    s_add_u32 s24, s24, s26
    s_mul_i32 s24, s24, 896
    s_mul_i32 s25, s25, 448
    s_add_u32 s24, s24, s25
    s_lshr_b32 s26, s19, 1
    s_mul_i32 s26, s26, 224
    s_add_u32 s24, s24, s26
    s_lshr_b32 s26, s20, 1
    s_lshl_b32 s26, s26, 5
    s_add_u32 s24, s24, s26
    s_lshl_b32 s24, s24, 1
    v_and_b32 v3, 15, v1
    v_mul_u32_u24 v3, 1792, v3
    v_lshrrev_b32 v4, 4, v1
    v_lshlrev_b32 v4, 3, v4
    v_add_u32 v3, v3, v4
    s_waitcnt vmcnt(7)
    v_lshlrev_b32 v48, 16, v8
    v_and_b32 v49, 0xffff0000, v8
    v_lshlrev_b32 v50, 16, v9
    v_and_b32 v51, 0xffff0000, v9
    v_lshlrev_b32 v52, 16, v10
    v_and_b32 v53, 0xffff0000, v10
    v_lshlrev_b32 v54, 16, v11
    v_and_b32 v55, 0xffff0000, v11
    s_waitcnt vmcnt(6)
    v_lshlrev_b32 v5, 16, v12
    v_and_b32 v6, 0xffff0000, v12
    v_add_f32 v48, v48, v5
    v_add_f32 v49, v49, v6
    v_lshlrev_b32 v5, 16, v13
    v_and_b32 v6, 0xffff0000, v13
    v_add_f32 v50, v50, v5
    v_add_f32 v51, v51, v6
    v_lshlrev_b32 v5, 16, v14
    v_and_b32 v6, 0xffff0000, v14
    v_add_f32 v52, v52, v5
    v_add_f32 v53, v53, v6
    v_lshlrev_b32 v5, 16, v15
    v_and_b32 v6, 0xffff0000, v15
    v_add_f32 v54, v54, v5
    v_add_f32 v55, v55, v6
    s_waitcnt vmcnt(5)
    v_lshlrev_b32 v5, 16, v16
    v_and_b32 v6, 0xffff0000, v16
    v_add_f32 v48, v48, v5
    v_add_f32 v49, v49, v6
    v_lshlrev_b32 v5, 16, v17
    v_and_b32 v6, 0xffff0000, v17
    v_add_f32 v50, v50, v5
    v_add_f32 v51, v51, v6
    v_lshlrev_b32 v5, 16, v18
    v_and_b32 v6, 0xffff0000, v18
    v_add_f32 v52, v52, v5
    v_add_f32 v53, v53, v6
    v_lshlrev_b32 v5, 16, v19
    v_and_b32 v6, 0xffff0000, v19
    v_add_f32 v54, v54, v5
    v_add_f32 v55, v55, v6
    s_waitcnt vmcnt(4)
    v_lshlrev_b32 v5, 16, v20
    v_and_b32 v6, 0xffff0000, v20
    v_add_f32 v48, v48, v5
    v_add_f32 v49, v49, v6
    v_lshlrev_b32 v5, 16, v21
    v_and_b32 v6, 0xffff0000, v21
    v_add_f32 v50, v50, v5
    v_add_f32 v51, v51, v6
    v_lshlrev_b32 v5, 16, v22
    v_and_b32 v6, 0xffff0000, v22
    v_add_f32 v52, v52, v5
    v_add_f32 v53, v53, v6
    v_lshlrev_b32 v5, 16, v23
    v_and_b32 v6, 0xffff0000, v23
    v_add_f32 v54, v54, v5
    v_add_f32 v55, v55, v6
    s_waitcnt vmcnt(3)
    v_lshlrev_b32 v5, 16, v24
    v_and_b32 v6, 0xffff0000, v24
    v_add_f32 v48, v48, v5
    v_add_f32 v49, v49, v6
    v_lshlrev_b32 v5, 16, v25
    v_and_b32 v6, 0xffff0000, v25
    v_add_f32 v50, v50, v5
    v_add_f32 v51, v51, v6
    v_lshlrev_b32 v5, 16, v26
    v_and_b32 v6, 0xffff0000, v26
    v_add_f32 v52, v52, v5
    v_add_f32 v53, v53, v6
    v_lshlrev_b32 v5, 16, v27
    v_and_b32 v6, 0xffff0000, v27
    v_add_f32 v54, v54, v5
    v_add_f32 v55, v55, v6
    s_waitcnt vmcnt(2)
    v_lshlrev_b32 v5, 16, v28
    v_and_b32 v6, 0xffff0000, v28
    v_add_f32 v48, v48, v5
    v_add_f32 v49, v49, v6
    v_lshlrev_b32 v5, 16, v29
    v_and_b32 v6, 0xffff0000, v29
    v_add_f32 v50, v50, v5
    v_add_f32 v51, v51, v6
    v_lshlrev_b32 v5, 16, v30
    v_and_b32 v6, 0xffff0000, v30
    v_add_f32 v52, v52, v5
    v_add_f32 v53, v53, v6
    v_lshlrev_b32 v5, 16, v31
    v_and_b32 v6, 0xffff0000, v31
    v_add_f32 v54, v54, v5
    v_add_f32 v55, v55, v6
    s_waitcnt vmcnt(1)
    v_lshlrev_b32 v5, 16, v32
    v_and_b32 v6, 0xffff0000, v32
    v_add_f32 v48, v48, v5
    v_add_f32 v49, v49, v6
    v_lshlrev_b32 v5, 16, v33
    v_and_b32 v6, 0xffff0000, v33
    v_add_f32 v50, v50, v5
    v_add_f32 v51, v51, v6
    v_lshlrev_b32 v5, 16, v34
    v_and_b32 v6, 0xffff0000, v34
    v_add_f32 v52, v52, v5
    v_add_f32 v53, v53, v6
    v_lshlrev_b32 v5, 16, v35
    v_and_b32 v6, 0xffff0000, v35
    v_add_f32 v54, v54, v5
    v_add_f32 v55, v55, v6
    s_waitcnt vmcnt(0)
    v_lshlrev_b32 v5, 16, v36
    v_and_b32 v6, 0xffff0000, v36
    v_add_f32 v48, v48, v5
    v_add_f32 v49, v49, v6
    v_lshlrev_b32 v5, 16, v37
    v_and_b32 v6, 0xffff0000, v37
    v_add_f32 v50, v50, v5
    v_add_f32 v51, v51, v6
    v_lshlrev_b32 v5, 16, v38
    v_and_b32 v6, 0xffff0000, v38
    v_add_f32 v52, v52, v5
    v_add_f32 v53, v53, v6
    v_lshlrev_b32 v5, 16, v39
    v_and_b32 v6, 0xffff0000, v39
    v_add_f32 v54, v54, v5
    v_add_f32 v55, v55, v6
    v_cvt_pk_bf16_f32 v56, v48, v49
    v_cvt_pk_bf16_f32 v57, v50, v51
    v_cvt_pk_bf16_f32 v58, v52, v53
    v_cvt_pk_bf16_f32 v59, v54, v55
    buffer_store_dwordx2 v[56:57], v3, s[12:15], s24 offen
    buffer_store_dwordx2 v[58:59], v3, s[12:15], s24 offen offset:32
R_exit:
    s_endpgm
.section .rodata,"a"
.p2align 6
.amdhsa_kernel concat_heads__gqa_block_cached__gqa_block_cached__near_ridge_kernel
  .amdhsa_next_free_vgpr 256
  .amdhsa_next_free_sgpr 102
  .amdhsa_accum_offset 256
  .amdhsa_group_segment_fixed_size 0
  .amdhsa_kernarg_size 104
  .amdhsa_user_sgpr_count 2
  .amdhsa_user_sgpr_kernarg_segment_ptr 1
  .amdhsa_system_sgpr_workgroup_id_x 1
.end_amdhsa_kernel

.p2align 6
.amdhsa_kernel reduce_partials_kernel
  .amdhsa_next_free_vgpr 64
  .amdhsa_next_free_sgpr 32
  .amdhsa_accum_offset 64
  .amdhsa_group_segment_fixed_size 0
  .amdhsa_kernarg_size 104
  .amdhsa_user_sgpr_count 2
  .amdhsa_user_sgpr_kernarg_segment_ptr 1
  .amdhsa_system_sgpr_workgroup_id_x 1
.end_amdhsa_kernel
```
